```python
import torch

def _softmax(x, axis=-1):
    return torch.softmax(x, dim=axis)
def _gelu(x):
    return torch.nn.functional.gelu(x, approximate="tanh")
def _silu(x):
    return torch.nn.functional.silu(x)
def _sigmoid(x):
    return torch.sigmoid(x)
def _layernorm(x, axis=-1, eps=1e-5):
    m = x.mean(dim=axis, keepdim=True)
    v = x.var(dim=axis, keepdim=True, unbiased=False)
    return (x - m) / torch.sqrt(v + eps)
def _scatter_add(tgt, idx, src, axis=0):
    return tgt.clone().index_add_(axis, idx, src)
def _segment_sum(src, seg, n):
    out = torch.zeros((n,) + src.shape[1:], dtype=src.dtype)
    return out.index_add_(0, seg, src)
def _pad(x, pw):
    flat = tuple(v for pair in reversed(pw) for v in pair)
    return torch.nn.functional.pad(x, flat)

kernel_name = 'concat_heads__spectral_fnet__sliding_local_dilated__prompt'

def setup_inputs():

    _w = (lambda a: (lambda t: t.to(torch.bfloat16) if t.is_floating_point() else t)(torch.as_tensor(a)))
    def _A_setup():
        B, S, D = 1, 2048, 512
        ns = torch.arange(S)[:, None] * torch.arange(S)[None, :]
        nd = torch.arange(D)[:, None] * torch.arange(D)[None, :]
        Ws_re = torch.cos(-2.0 * torch.pi * ns / S).to(float)
        Ws_im = torch.sin(-2.0 * torch.pi * ns / S).to(float)
        Wd_re = torch.cos(-2.0 * torch.pi * nd / D).to(float)
        Wd_im = torch.sin(-2.0 * torch.pi * nd / D).to(float)
        return {
            "x": _w((lambda *s: torch.randn(*s, dtype=torch.bfloat16) * 0.05)(B, S, D)),
            "dft_seq_re": _w(Ws_re),
            "dft_seq_im": _w(Ws_im),
            "dft_hid_re": _w(Wd_re),
            "dft_hid_im": _w(Wd_im),
        }
    _A_in = _A_setup()

    def _B_setup():
        B, S, D = 1, 2048, 512
        return {
            "x": _w((lambda *s: torch.randn(*s, dtype=torch.bfloat16) * 0.2)(B, S, D)),
            "wqkv": _w((lambda *s: torch.randn(*s, dtype=torch.bfloat16) * 0.8)(D, 3 * D)),
            "wo": _w((lambda *s: torch.randn(*s, dtype=torch.bfloat16) * 0.2)(D, D)),
        }
    _B_in = _B_setup()

    return {
        "A_x": _A_in["x"],
        "A_dft_seq_re": _A_in["dft_seq_re"],
        "A_dft_seq_im": _A_in["dft_seq_im"],
        "A_dft_hid_re": _A_in["dft_hid_re"],
        "A_dft_hid_im": _A_in["dft_hid_im"],
        "B_x": _B_in["x"],
        "B_wqkv": _B_in["wqkv"],
        "B_wo": _B_in["wo"],
    }

def reference(A_x, A_dft_seq_re, A_dft_seq_im, A_dft_hid_re, A_dft_hid_im, B_x, B_wqkv, B_wo):
    def _A_ref(x, dft_seq_re, dft_seq_im, dft_hid_re, dft_hid_im):
        a = torch.einsum("bsd,ed->bse", x, dft_hid_re)
        b = torch.einsum("bsd,ed->bse", x, dft_hid_im)
        y = torch.einsum("ts,bse->bte", dft_seq_re, a) - torch.einsum("ts,bse->bte", dft_seq_im, b)
        return y

    def _B_ref(x, wqkv, wo):
        B, S, D = x.shape
        H = 32; Dh = D // H
        W, dil = 8, 2
        qkv = (lambda x, *d: x.permute(*d))((x @ wqkv).reshape(B, S, 3, H, Dh), 2, 0, 3, 1, 4)
        q, k, v = qkv[0], qkv[1], qkv[2]
        scale = Dh ** -0.5
        pos = torch.arange(S)
        off = torch.arange(W) * dil
        idx = pos[:, None] - off[None, :]
        mask = idx >= 0
        idx_c = torch.where(mask, idx, 0).reshape(-1)
        kg = k[:, :, idx_c, :].reshape(B, H, S, W, Dh)
        vg = v[:, :, idx_c, :].reshape(B, H, S, W, Dh)
        logits = torch.einsum("bhsd,bhswd->bhsw", q, kg) * scale
        logits = torch.where(mask[None, None, :, :], logits, -1e9)
        attn = _softmax(logits, axis=-1)
        o = torch.einsum("bhsw,bhswd->bhsd", attn, vg)
        return (lambda x, *d: x.permute(*d))(o, 0, 2, 1, 3).reshape(B, S, D) @ wo

    a = _A_ref(A_x, A_dft_seq_re, A_dft_seq_im, A_dft_hid_re, A_dft_hid_im)
    b = _B_ref(B_x, B_wqkv, B_wo)
    return torch.concatenate([a, b], axis=-1)
```

```asm
; @launch grid=(256,1,1) block=(512,1,1) lds=163840
.amdgcn_target "amdgcn-amd-amdhsa--gfx950"
.text
.globl concat_heads__spectral_fnet__sliding_local_dilated__prompt_kernel
.p2align 8
.type concat_heads__spectral_fnet__sliding_local_dilated__prompt_kernel,@function
concat_heads__spectral_fnet__sliding_local_dilated__prompt_kernel:
  s_cmp_ge_u32 s2, 256
  s_cbranch_scc1 L_exit
  s_load_dwordx2 s[4:5], s[0:1], 0
  s_load_dwordx2 s[6:7], s[0:1], 8
  s_load_dwordx2 s[8:9], s[0:1], 16
  s_load_dwordx2 s[10:11], s[0:1], 80
  s_load_dwordx4 s[44:47], s[0:1], 24
  s_load_dwordx4 s[48:51], s[0:1], 56
  s_load_dwordx2 s[62:63], s[0:1], 72
  v_lshrrev_b32 v1, 6, v0
  s_nop 0
  v_readfirstlane_b32 s3, v1
  v_and_b32 v1, 63, v0
  s_and_b32 s72, s2, 7
  s_lshl_b32 s72, s72, 2
  s_lshr_b32 s73, s2, 6
  s_add_u32 s72, s72, s73
  s_bfe_u32 s73, s2, 0x30003
  s_bfe_u32 s88, s2, 0x10006
  s_lshl_b32 s88, s88, 2
  s_lshr_b32 s89, s2, 7
  s_lshl_b32 s89, s89, 1
  s_add_u32 s88, s88, s89
  s_add_u32 s88, s88, s73
  s_and_b32 s88, s88, 7
  s_mov_b32 s58, 524288
  s_mov_b32 s59, 0x00020000
  s_cmp_ge_u32 s2, 128
  s_cbranch_scc1 L_partb
  s_and_b32 s12, s2, 7
  s_lshr_b32 s13, s2, 3
  s_lshr_b32 s14, s13, 3
  s_bfe_u32 s15, s13, 0x10002
  s_lshl_b32 s12, s12, 1
  s_add_u32 s15, s15, s12
  s_and_b32 s16, s13, 3
  s_lshr_b32 s17, s13, 2
  s_add_u32 s17, s17, s16
  s_and_b32 s17, s17, 3
  s_cmp_ge_u32 s3, 4
  s_cbranch_scc0 L_big_cons
  s_sub_u32 s18, s3, 4
  v_lshrrev_b32 v2, 4, v1
  v_and_b32 v3, 15, v1
  v_lshlrev_b32 v4, 2, v2
  v_xor_b32 v3, v3, v4
  s_lshl_b32 s19, s18, 4
  v_add_u32 v4, s19, v2
  v_lshlrev_b32 v4, 10, v4
  v_lshl_add_u32 v4, v3, 4, v4
  s_lshl_b32 s19, s16, 8
  v_add_u32 v4, s19, v4
  v_add_u32 v10, 0, v4
  v_add_u32 v11, 3072, v4
  v_add_u32 v12, 6144, v4
  v_add_u32 v13, 9216, v4
  v_lshrrev_b32 v4, 3, v1
  v_and_b32 v3, 7, v1
  v_xor_b32 v3, v3, v2
  v_xor_b32 v5, 4, v3
  s_lshl_b32 s19, s18, 5
  s_lshl_b32 s22, s15, 7
  s_add_u32 s19, s19, s22
  v_add_u32 v4, s19, v4
  v_lshlrev_b32 v4, 12, v4
  v_lshl_add_u32 v6, v3, 4, v4
  v_lshl_add_u32 v7, v5, 4, v4
  v_add_u32 v14, 0, v6
  v_add_u32 v15, 31744, v7
  v_add_u32 v16, 63488, v6
  v_add_u32 v17, 95232, v7
  v_add_u32 v20, -1, v1
  v_and_b32 v21, 3, v20
  v_and_b32 v22, -4, v20
  v_cmp_lt_u32 vcc, s17, v21
  s_nop 1
  v_subbrev_co_u32 v25, vcc, 0, v21, vcc
  v_add_u32 v26, -28, v20
  v_mul_u32_u24 v27, 11, v26
  v_lshrrev_b32 v27, 5, v27
  v_mul_u32_u24 v28, 3, v27
  v_sub_u32 v28, v26, v28
  v_lshl_add_u32 v27, v27, 2, 28
  v_cmp_le_u32 vcc, 29, v1
  v_mov_b32 v29, -1
  s_nop 0
  v_cndmask_b32 v22, v22, v27, vcc
  v_cndmask_b32 v25, v25, v28, vcc
  v_cndmask_b32 v21, v21, v29, vcc
  s_add_u32 s36, s17, 1
  v_add_u32 v23, s36, v25
  v_and_b32 v23, 3, v23
  v_add_u32 v23, v22, v23
  s_add_u32 s36, s17, 36
  v_add_u32 v24, s36, v22
  v_cmp_eq_u32 vcc, s17, v21
  s_nop 1
  v_cndmask_b32 v23, v23, v24, vcc
  s_add_u32 s36, s17, 32
  v_lshl_add_u32 v24, v1, 2, s36
  v_cmp_gt_u32 vcc, 1, v1
  s_nop 1
  v_cndmask_b32 v23, v23, v24, vcc
  s_mov_b32 s36, 0
  s_mul_i32 s39, s12, 0
  s_lshl_b32 s34, s18, 12
  s_add_u32 s35, s34, 16384
  s_mov_b32 s20, 0
  v_readlane_b32 s37, v23, s36
  s_add_u32 s36, s36, 1
  s_and_b32 s36, s36, 31
  s_add_u32 s38, s37, s39
  s_and_b32 s38, s38, 31
  s_lshl_b32 s32, s38, 16
  s_lshl_b32 s33, s38, 7
  s_waitcnt lgkmcnt(0)
  s_mov_b32 s24, s4
  s_mov_b32 s25, s5
  s_mov_b32 s26, 2097152
  s_mov_b32 s27, 0x00020000
  s_cmp_eq_u32 s14, 0
  s_cselect_b32 s28, s6, s8
  s_cselect_b32 s29, s7, s9
  s_mov_b32 s30, 8388608
  s_mov_b32 s31, 0x00020000
  s_add_u32 m0, s20, s35
  s_nop 0
  buffer_load_dwordx4 v14, s[28:31], s33 offen offset:0 lds
  buffer_load_dwordx4 v15, s[28:31], s33 offen offset:1024 lds
  buffer_load_dwordx4 v16, s[28:31], s33 offen offset:2048 lds
  buffer_load_dwordx4 v17, s[28:31], s33 offen offset:3072 lds
  s_add_u32 m0, s20, s34
  s_nop 0
  buffer_load_dwordx4 v10, s[24:27], s32 offen offset:0 lds
  buffer_load_dwordx4 v11, s[24:27], s32 offen offset:1024 lds
  buffer_load_dwordx4 v12, s[24:27], s32 offen offset:2048 lds
  buffer_load_dwordx4 v13, s[24:27], s32 offen offset:3072 lds
  v_readlane_b32 s37, v23, s36
  s_add_u32 s36, s36, 1
  s_and_b32 s36, s36, 31
  s_add_u32 s38, s37, s39
  s_and_b32 s38, s38, 31
  s_lshl_b32 s32, s38, 16
  s_lshl_b32 s33, s38, 7
  s_add_u32 s20, s20, 32768
  s_cmp_ge_u32 s20, 163840
  s_cselect_b32 s20, 0, s20
  s_add_u32 m0, s20, s35
  s_nop 0
  buffer_load_dwordx4 v14, s[28:31], s33 offen offset:0 lds
  buffer_load_dwordx4 v15, s[28:31], s33 offen offset:1024 lds
  buffer_load_dwordx4 v16, s[28:31], s33 offen offset:2048 lds
  buffer_load_dwordx4 v17, s[28:31], s33 offen offset:3072 lds
  s_add_u32 m0, s20, s34
  s_nop 0
  buffer_load_dwordx4 v10, s[24:27], s32 offen offset:0 lds
  buffer_load_dwordx4 v11, s[24:27], s32 offen offset:1024 lds
  buffer_load_dwordx4 v12, s[24:27], s32 offen offset:2048 lds
  buffer_load_dwordx4 v13, s[24:27], s32 offen offset:3072 lds
  v_readlane_b32 s37, v23, s36
  s_add_u32 s36, s36, 1
  s_and_b32 s36, s36, 31
  s_add_u32 s38, s37, s39
  s_and_b32 s38, s38, 31
  s_lshl_b32 s32, s38, 16
  s_lshl_b32 s33, s38, 7
  s_add_u32 s20, s20, 32768
  s_cmp_ge_u32 s20, 163840
  s_cselect_b32 s20, 0, s20
  s_add_u32 m0, s20, s35
  s_nop 0
  buffer_load_dwordx4 v14, s[28:31], s33 offen offset:0 lds
  buffer_load_dwordx4 v15, s[28:31], s33 offen offset:1024 lds
  buffer_load_dwordx4 v16, s[28:31], s33 offen offset:2048 lds
  buffer_load_dwordx4 v17, s[28:31], s33 offen offset:3072 lds
  s_add_u32 m0, s20, s34
  s_nop 0
  buffer_load_dwordx4 v10, s[24:27], s32 offen offset:0 lds
  buffer_load_dwordx4 v11, s[24:27], s32 offen offset:1024 lds
  buffer_load_dwordx4 v12, s[24:27], s32 offen offset:2048 lds
  buffer_load_dwordx4 v13, s[24:27], s32 offen offset:3072 lds
  v_readlane_b32 s37, v23, s36
  s_add_u32 s36, s36, 1
  s_and_b32 s36, s36, 31
  s_add_u32 s38, s37, s39
  s_and_b32 s38, s38, 31
  s_lshl_b32 s32, s38, 16
  s_lshl_b32 s33, s38, 7
  s_add_u32 s20, s20, 32768
  s_cmp_ge_u32 s20, 163840
  s_cselect_b32 s20, 0, s20
  s_add_u32 m0, s20, s35
  s_nop 0
  buffer_load_dwordx4 v14, s[28:31], s33 offen offset:0 lds
  buffer_load_dwordx4 v15, s[28:31], s33 offen offset:1024 lds
  buffer_load_dwordx4 v16, s[28:31], s33 offen offset:2048 lds
  buffer_load_dwordx4 v17, s[28:31], s33 offen offset:3072 lds
  s_add_u32 m0, s20, s34
  s_nop 0
  buffer_load_dwordx4 v10, s[24:27], s32 offen offset:0 lds
  buffer_load_dwordx4 v11, s[24:27], s32 offen offset:1024 lds
  buffer_load_dwordx4 v12, s[24:27], s32 offen offset:2048 lds
  buffer_load_dwordx4 v13, s[24:27], s32 offen offset:3072 lds
  v_readlane_b32 s37, v23, s36
  s_add_u32 s36, s36, 1
  s_and_b32 s36, s36, 31
  s_add_u32 s38, s37, s39
  s_and_b32 s38, s38, 31
  s_lshl_b32 s32, s38, 16
  s_lshl_b32 s33, s38, 7
  s_add_u32 s20, s20, 32768
  s_cmp_ge_u32 s20, 163840
  s_cselect_b32 s20, 0, s20
  s_mov_b32 s64, s10
  s_mov_b32 s65, s11
  s_mov_b32 s66, 8527872
  s_mov_b32 s67, 0x00020000
  s_mov_b32 s68, s62
  s_mov_b32 s69, s63
  s_mov_b32 s70, 256
  s_mov_b32 s71, 0x00020000
  s_sub_u32 s18, s3, 4
  v_lshrrev_b32 v2, 3, v1
  v_and_b32 v3, 7, v1
  v_lshrrev_b32 v4, 4, v1
  v_xor_b32 v3, v3, v4
  v_xor_b32 v5, 4, v3
  s_lshl_b32 s19, s18, 4
  v_add_u32 v2, s19, v2
  s_lshl_b32 s19, s73, 6
  v_add_u32 v6, s19, v2
  v_lshlrev_b32 v6, 10, v6
  v_lshl_add_u32 v200, v3, 4, v6
  v_lshl_add_u32 v201, v5, 4, v6
  v_add_u32 v201, 7168, v201
  s_lshl_b32 s19, s72, 6
  v_add_u32 v6, s19, v2
  s_movk_i32 s19, 2048
  v_mul_lo_u32 v7, v6, s19
  v_lshl_add_u32 v202, v3, 4, v7
  v_lshl_add_u32 v203, v5, 4, v7
  v_add_u32 v203, 15360, v203
  s_lshr_b32 s19, s72, 1
  s_mul_i32 s22, s19, 4352
  s_add_u32 s22, s22, 8388608
  v_and_b32 v3, 31, v1
  v_lshl_add_u32 v208, v3, 3, s22
  s_lshl_b32 s52, s18, 11
  s_mov_b32 s21, 28
L_big_ld:
  s_waitcnt vmcnt(24)
  s_barrier
  s_add_u32 m0, s20, s35
  s_nop 0
  buffer_load_dwordx4 v14, s[28:31], s33 offen offset:0 lds
  buffer_load_dwordx4 v15, s[28:31], s33 offen offset:1024 lds
  buffer_load_dwordx4 v16, s[28:31], s33 offen offset:2048 lds
  buffer_load_dwordx4 v17, s[28:31], s33 offen offset:3072 lds
  s_add_u32 m0, s20, s34
  s_nop 0
  buffer_load_dwordx4 v10, s[24:27], s32 offen offset:0 lds
  buffer_load_dwordx4 v11, s[24:27], s32 offen offset:1024 lds
  buffer_load_dwordx4 v12, s[24:27], s32 offen offset:2048 lds
  buffer_load_dwordx4 v13, s[24:27], s32 offen offset:3072 lds
  v_readlane_b32 s37, v23, s36
  s_add_u32 s36, s36, 1
  s_and_b32 s36, s36, 31
  s_add_u32 s38, s37, s39
  s_and_b32 s38, s38, 31
  s_lshl_b32 s32, s38, 16
  s_lshl_b32 s33, s38, 7
  s_add_u32 s20, s20, 32768
  s_cmp_ge_u32 s20, 163840
  s_cselect_b32 s20, 0, s20
  s_sub_u32 s21, s21, 1
  s_cmp_lg_u32 s21, 0
  s_cbranch_scc1 L_big_ld
  s_waitcnt vmcnt(24)
  s_barrier
  s_lshl_b32 s53, s88, 1
  s_add_u32 s53, s53, 4
  s_bitcmp1_b32 s53, 3
  s_cselect_b32 s56, s46, s44
  s_cselect_b32 s57, s47, s45
  s_and_b32 s53, s53, 7
  s_lshl_b32 s53, s53, 7
  s_add_u32 m0, s52, 65536
  s_nop 0
  buffer_load_dwordx4 v200, s[56:59], s53 offen lds
  buffer_load_dwordx4 v201, s[56:59], s53 offen offset:1024 lds
  s_lshl_b32 s53, s88, 1
  s_add_u32 s53, s53, 5
  s_bitcmp1_b32 s53, 3
  s_cselect_b32 s56, s46, s44
  s_cselect_b32 s57, s47, s45
  s_and_b32 s53, s53, 7
  s_lshl_b32 s53, s53, 7
  s_add_u32 m0, s52, 73728
  s_nop 0
  buffer_load_dwordx4 v200, s[56:59], s53 offen lds
  buffer_load_dwordx4 v201, s[56:59], s53 offen offset:1024 lds
  s_lshl_b32 s53, s88, 1
  s_add_u32 s53, s53, 6
  s_bitcmp1_b32 s53, 3
  s_cselect_b32 s56, s46, s44
  s_cselect_b32 s57, s47, s45
  s_and_b32 s53, s53, 7
  s_lshl_b32 s53, s53, 7
  s_add_u32 m0, s52, 81920
  s_nop 0
  buffer_load_dwordx4 v200, s[56:59], s53 offen lds
  buffer_load_dwordx4 v201, s[56:59], s53 offen offset:1024 lds
  s_lshl_b32 s53, s88, 1
  s_add_u32 s53, s53, 7
  s_bitcmp1_b32 s53, 3
  s_cselect_b32 s56, s46, s44
  s_cselect_b32 s57, s47, s45
  s_and_b32 s53, s53, 7
  s_lshl_b32 s53, s53, 7
  s_add_u32 m0, s52, 90112
  s_nop 0
  buffer_load_dwordx4 v200, s[56:59], s53 offen lds
  buffer_load_dwordx4 v201, s[56:59], s53 offen offset:1024 lds
  v_mov_b32 v234, 0
  buffer_load_dwordx2 v[232:233], v234, s[68:71], 0 offen sc1
  s_waitcnt vmcnt(25)
  s_barrier
  s_waitcnt vmcnt(17)
  s_barrier
  s_waitcnt vmcnt(9)
  s_barrier
  s_lshl_b32 s53, s88, 1
  s_add_u32 s53, s53, 8
  s_bitcmp1_b32 s53, 3
  s_cselect_b32 s56, s46, s44
  s_cselect_b32 s57, s47, s45
  s_and_b32 s53, s53, 7
  s_lshl_b32 s53, s53, 7
  s_add_u32 m0, s52, 98304
  s_nop 0
  buffer_load_dwordx4 v200, s[56:59], s53 offen lds
  buffer_load_dwordx4 v201, s[56:59], s53 offen offset:1024 lds
  s_lshl_b32 s53, s88, 1
  s_add_u32 s53, s53, 9
  s_bitcmp1_b32 s53, 3
  s_cselect_b32 s56, s46, s44
  s_cselect_b32 s57, s47, s45
  s_and_b32 s53, s53, 7
  s_lshl_b32 s53, s53, 7
  s_add_u32 m0, s52, 106496
  s_nop 0
  buffer_load_dwordx4 v200, s[56:59], s53 offen lds
  buffer_load_dwordx4 v201, s[56:59], s53 offen offset:1024 lds
  s_lshl_b32 s53, s88, 1
  s_add_u32 s53, s53, 10
  s_bitcmp1_b32 s53, 3
  s_cselect_b32 s56, s46, s44
  s_cselect_b32 s57, s47, s45
  s_and_b32 s53, s53, 7
  s_lshl_b32 s53, s53, 7
  s_add_u32 m0, s52, 114688
  s_nop 0
  buffer_load_dwordx4 v200, s[56:59], s53 offen lds
  buffer_load_dwordx4 v201, s[56:59], s53 offen offset:1024 lds
  s_lshl_b32 s53, s88, 1
  s_add_u32 s53, s53, 11
  s_bitcmp1_b32 s53, 3
  s_cselect_b32 s56, s46, s44
  s_cselect_b32 s57, s47, s45
  s_and_b32 s53, s53, 7
  s_lshl_b32 s53, s53, 7
  s_add_u32 m0, s52, 122880
  s_nop 0
  buffer_load_dwordx4 v200, s[56:59], s53 offen lds
  buffer_load_dwordx4 v201, s[56:59], s53 offen offset:1024 lds
  s_lshl_b32 s53, s88, 1
  s_add_u32 s53, s53, 0
  s_bitcmp1_b32 s53, 3
  s_cselect_b32 s56, s46, s44
  s_cselect_b32 s57, s47, s45
  s_and_b32 s53, s53, 7
  s_lshl_b32 s53, s53, 7
  s_add_u32 m0, s52, 0
  s_nop 0
  buffer_load_dwordx4 v200, s[56:59], s53 offen lds
  buffer_load_dwordx4 v201, s[56:59], s53 offen offset:1024 lds
  s_lshl_b32 s53, s88, 1
  s_add_u32 s53, s53, 1
  s_bitcmp1_b32 s53, 3
  s_cselect_b32 s56, s46, s44
  s_cselect_b32 s57, s47, s45
  s_and_b32 s53, s53, 7
  s_lshl_b32 s53, s53, 7
  s_add_u32 m0, s52, 8192
  s_nop 0
  buffer_load_dwordx4 v200, s[56:59], s53 offen lds
  buffer_load_dwordx4 v201, s[56:59], s53 offen offset:1024 lds
  s_lshl_b32 s53, s88, 1
  s_add_u32 s53, s53, 2
  s_bitcmp1_b32 s53, 3
  s_cselect_b32 s56, s46, s44
  s_cselect_b32 s57, s47, s45
  s_and_b32 s53, s53, 7
  s_lshl_b32 s53, s53, 7
  s_add_u32 m0, s52, 16384
  s_nop 0
  buffer_load_dwordx4 v200, s[56:59], s53 offen lds
  buffer_load_dwordx4 v201, s[56:59], s53 offen offset:1024 lds
  s_lshl_b32 s53, s88, 1
  s_add_u32 s53, s53, 3
  s_bitcmp1_b32 s53, 3
  s_cselect_b32 s56, s46, s44
  s_cselect_b32 s57, s47, s45
  s_and_b32 s53, s53, 7
  s_lshl_b32 s53, s53, 7
  s_add_u32 m0, s52, 24576
  s_nop 0
  buffer_load_dwordx4 v200, s[56:59], s53 offen lds
  buffer_load_dwordx4 v201, s[56:59], s53 offen offset:1024 lds
L_nn_1:
  s_waitcnt vmcnt(0)
  v_readfirstlane_b32 s74, v232
  v_readfirstlane_b32 s75, v233
  s_nop 0
  s_cmp_lg_u32 s74, 0
  s_cbranch_scc1 L_nd_2
  buffer_load_dwordx2 v[232:233], v234, s[68:71], 0 offen sc1
  s_branch L_nn_1
L_nd_2:
  s_barrier
  s_branch L_y_loader
L_big_cons:
  s_and_b32 s18, s3, 1
  s_lshr_b32 s19, s3, 1
  v_and_b32 v2, 31, v1
  v_bfe_u32 v3, v2, 1, 3
  v_lshrrev_b32 v5, 5, v1
  v_xor_b32 v3, v3, v5
  v_lshlrev_b32 v4, 7, v2
  s_lshl_b32 s22, s18, 12
  s_lshl_b32 s23, s19, 12
  v_xor_b32 v6, 0, v3
  v_lshl_add_u32 v6, v6, 4, v4
  v_add_u32 v212, s22, v6
  v_add_u32 v220, s23, v6
  v_add_u32 v216, 0x10000, v212
  v_add_u32 v224, 0x20000, v220
  v_xor_b32 v6, 2, v3
  v_lshl_add_u32 v6, v6, 4, v4
  v_add_u32 v213, s22, v6
  v_add_u32 v221, s23, v6
  v_add_u32 v217, 0x10000, v213
  v_add_u32 v225, 0x20000, v221
  v_xor_b32 v6, 4, v3
  v_lshl_add_u32 v6, v6, 4, v4
  v_add_u32 v214, s22, v6
  v_add_u32 v222, s23, v6
  v_add_u32 v218, 0x10000, v214
  v_add_u32 v226, 0x20000, v222
  v_xor_b32 v6, 6, v3
  v_lshl_add_u32 v6, v6, 4, v4
  v_add_u32 v215, s22, v6
  v_add_u32 v223, s23, v6
  v_add_u32 v219, 0x10000, v215
  v_add_u32 v227, 0x20000, v223
  s_lshl_b32 s22, s72, 6
  s_lshl_b32 s23, s19, 5
  s_add_u32 s22, s22, s23
  v_add_u32 v6, s22, v2
  v_lshlrev_b32 v6, 11, v6
  v_lshl_add_u32 v6, v5, 4, v6
  s_lshl_b32 s22, s73, 7
  s_lshl_b32 s23, s18, 6
  s_add_u32 s22, s22, s23
  v_add_u32 v238, s22, v6
  v_bfe_u32 v2, v1, 2, 2
  v_and_b32 v3, 3, v1
  v_bfe_u32 v4, v1, 4, 1
  v_lshlrev_b32 v6, 7, v2
  v_lshl_add_u32 v6, v5, 10, v6
  v_lshl_add_u32 v6, v4, 5, v6
  v_lshl_add_u32 v6, v3, 3, v6
  v_lshrrev_b32 v7, 1, v2
  v_xor_b32 v7, s18, v7
  v_lshl_add_u32 v236, v7, 6, v6
  v_add_u32 v237, 0x20000, v236
  s_and_b32 s18, s3, 1
  s_lshr_b32 s19, s3, 1
  v_bfe_u32 v2, v1, 2, 2
  v_and_b32 v3, 3, v1
  v_bfe_u32 v4, v1, 4, 1
  v_lshrrev_b32 v5, 5, v1
  v_lshlrev_b32 v6, 8, v2
  v_lshl_add_u32 v6, v5, 11, v6
  v_lshl_add_u32 v6, v4, 5, v6
  v_lshl_add_u32 v6, v3, 3, v6
  s_lshl_b32 s22, s18, 1
  s_add_u32 s23, s22, 0
  v_xor_b32 v7, s23, v2
  v_lshl_add_u32 v10, v7, 6, v6
  s_add_u32 s23, s22, 1
  v_xor_b32 v7, s23, v2
  v_lshl_add_u32 v11, v7, 6, v6
  v_and_b32 v2, 31, v1
  s_lshl_b32 s22, s19, 6
  v_add_u32 v2, s22, v2
  v_bfe_u32 v3, v2, 1, 3
  v_xor_b32 v3, v3, v5
  v_lshlrev_b32 v4, 7, v2
  v_add_u32 v4, 16384, v4
  v_xor_b32 v6, 0, v3
  v_lshl_add_u32 v12, v6, 4, v4
  v_xor_b32 v6, 2, v3
  v_lshl_add_u32 v13, v6, 4, v4
  v_xor_b32 v6, 4, v3
  v_lshl_add_u32 v14, v6, 4, v4
  v_xor_b32 v6, 6, v3
  v_lshl_add_u32 v15, v6, 4, v4
  v_and_b32 v2, 31, v1
  v_and_b32 v3, 7, v2
  v_xor_b32 v3, v3, v5
  v_lshlrev_b32 v4, 7, v2
  s_lshl_b32 s22, s3, 13
  s_add_u32 s22, s22, 131072
  v_add_u32 v4, s22, v4
  v_xor_b32 v6, 0, v3
  v_lshl_add_u32 v24, v6, 4, v4
  v_xor_b32 v6, 2, v3
  v_lshl_add_u32 v25, v6, 4, v4
  v_xor_b32 v6, 4, v3
  v_lshl_add_u32 v26, v6, 4, v4
  v_xor_b32 v6, 6, v3
  v_lshl_add_u32 v27, v6, 4, v4
  v_lshrrev_b32 v2, 3, v1
  v_and_b32 v3, 7, v1
  v_xor_b32 v4, v3, v2
  v_lshlrev_b32 v6, 7, v2
  v_lshl_add_u32 v6, v4, 4, v6
  v_add_u32 v28, s22, v6
  s_lshl_b32 s22, s15, 7
  s_lshl_b32 s23, s19, 6
  s_add_u32 s22, s22, s23
  v_add_u32 v2, s22, v2
  s_movk_i32 s22, 2048
  v_mul_lo_u32 v2, v2, s22
  v_lshl_add_u32 v2, v3, 4, v2
  s_lshl_b32 s22, s14, 10
  s_lshl_b32 s23, s16, 8
  s_add_u32 s22, s22, s23
  s_lshl_b32 s23, s18, 7
  s_add_u32 s22, s22, s23
  v_add_u32 v29, s22, v2
  v_mov_b32 v64, 0
  v_mov_b32 v65, 0
  v_mov_b32 v66, 0
  v_mov_b32 v67, 0
  v_mov_b32 v68, 0
  v_mov_b32 v69, 0
  v_mov_b32 v70, 0
  v_mov_b32 v71, 0
  v_mov_b32 v72, 0
  v_mov_b32 v73, 0
  v_mov_b32 v74, 0
  v_mov_b32 v75, 0
  v_mov_b32 v76, 0
  v_mov_b32 v77, 0
  v_mov_b32 v78, 0
  v_mov_b32 v79, 0
  v_mov_b32 v80, 0
  v_mov_b32 v81, 0
  v_mov_b32 v82, 0
  v_mov_b32 v83, 0
  v_mov_b32 v84, 0
  v_mov_b32 v85, 0
  v_mov_b32 v86, 0
  v_mov_b32 v87, 0
  v_mov_b32 v88, 0
  v_mov_b32 v89, 0
  v_mov_b32 v90, 0
  v_mov_b32 v91, 0
  v_mov_b32 v92, 0
  v_mov_b32 v93, 0
  v_mov_b32 v94, 0
  v_mov_b32 v95, 0
  v_mov_b32 v96, 0
  v_mov_b32 v97, 0
  v_mov_b32 v98, 0
  v_mov_b32 v99, 0
  v_mov_b32 v100, 0
  v_mov_b32 v101, 0
  v_mov_b32 v102, 0
  v_mov_b32 v103, 0
  v_mov_b32 v104, 0
  v_mov_b32 v105, 0
  v_mov_b32 v106, 0
  v_mov_b32 v107, 0
  v_mov_b32 v108, 0
  v_mov_b32 v109, 0
  v_mov_b32 v110, 0
  v_mov_b32 v111, 0
  v_mov_b32 v112, 0
  v_mov_b32 v113, 0
  v_mov_b32 v114, 0
  v_mov_b32 v115, 0
  v_mov_b32 v116, 0
  v_mov_b32 v117, 0
  v_mov_b32 v118, 0
  v_mov_b32 v119, 0
  v_mov_b32 v120, 0
  v_mov_b32 v121, 0
  v_mov_b32 v122, 0
  v_mov_b32 v123, 0
  v_mov_b32 v124, 0
  v_mov_b32 v125, 0
  v_mov_b32 v126, 0
  v_mov_b32 v127, 0
  s_mov_b32 s20, 0
  s_waitcnt lgkmcnt(0)
  s_mov_b32 s64, s10
  s_mov_b32 s65, s11
  s_mov_b32 s66, 8527872
  s_mov_b32 s67, 0x00020000
  s_mov_b32 s68, s62
  s_mov_b32 s69, s63
  s_mov_b32 s70, 256
  s_mov_b32 s71, 0x00020000
  s_or_b32 s22, s2, s3
  s_cmp_lg_u32 s22, 0
  s_cbranch_scc1 L_no_pub
  s_memrealtime s[22:23]
  s_waitcnt lgkmcnt(0)
  s_or_b32 s22, s22, 1
  v_mov_b32 v230, s22
  v_mov_b32 v231, s23
  v_mov_b32 v234, 0
  s_mov_b64 exec, 1
  buffer_store_dwordx2 v[230:231], v234, s[68:71], 0 offen sc1
  s_mov_b64 exec, -1
L_no_pub:
  s_barrier
  v_add_u32 v16, s20, v10
  v_add_u32 v17, s20, v11
  v_add_u32 v18, s20, v12
  v_add_u32 v19, s20, v13
  v_add_u32 v20, s20, v14
  v_add_u32 v21, s20, v15
  s_add_u32 s20, s20, 32768
  s_cmp_ge_u32 s20, 163840
  s_cselect_b32 s20, 0, s20
  ds_read_b128 v[136:139], v18
  ds_read_b64_tr_b16 v[128:129], v16 offset:0
  ds_read_b64_tr_b16 v[130:131], v16 offset:1024
  ds_read_b128 v[140:143], v18 offset:4096
  ds_read_b64_tr_b16 v[132:133], v17 offset:0
  ds_read_b64_tr_b16 v[134:135], v17 offset:1024
  ds_read_b128 v[152:155], v19
  ds_read_b64_tr_b16 v[144:145], v16 offset:4096
  ds_read_b64_tr_b16 v[146:147], v16 offset:5120
  ds_read_b128 v[156:159], v19 offset:4096
  ds_read_b64_tr_b16 v[148:149], v17 offset:4096
  ds_read_b64_tr_b16 v[150:151], v17 offset:5120
  s_mov_b32 s21, 31
L_big_loop:
  s_waitcnt lgkmcnt(6)
  v_mfma_f32_32x32x16_bf16 v[64:79], v[128:131], v[136:139], v[64:79]
  ds_read_b128 v[168:171], v20
  ds_read_b64_tr_b16 v[160:161], v16 offset:8192
  ds_read_b64_tr_b16 v[162:163], v16 offset:9216
  v_mfma_f32_32x32x16_bf16 v[80:95], v[128:131], v[140:143], v[80:95]
  ds_read_b128 v[172:175], v20 offset:4096
  ds_read_b64_tr_b16 v[164:165], v17 offset:8192
  ds_read_b64_tr_b16 v[166:167], v17 offset:9216
  v_mfma_f32_32x32x16_bf16 v[96:111], v[132:135], v[136:139], v[96:111]
  v_mfma_f32_32x32x16_bf16 v[112:127], v[132:135], v[140:143], v[112:127]
  s_waitcnt lgkmcnt(6)
  v_mfma_f32_32x32x16_bf16 v[64:79], v[144:147], v[152:155], v[64:79]
  ds_read_b128 v[184:187], v21
  ds_read_b64_tr_b16 v[176:177], v16 offset:12288
  ds_read_b64_tr_b16 v[178:179], v16 offset:13312
  v_mfma_f32_32x32x16_bf16 v[80:95], v[144:147], v[156:159], v[80:95]
  ds_read_b128 v[188:191], v21 offset:4096
  ds_read_b64_tr_b16 v[180:181], v17 offset:12288
  ds_read_b64_tr_b16 v[182:183], v17 offset:13312
  v_mfma_f32_32x32x16_bf16 v[96:111], v[148:151], v[152:155], v[96:111]
  v_add_u32 v16, s20, v10
  v_add_u32 v17, s20, v11
  v_add_u32 v18, s20, v12
  v_add_u32 v19, s20, v13
  v_add_u32 v20, s20, v14
  v_mfma_f32_32x32x16_bf16 v[112:127], v[148:151], v[156:159], v[112:127]
  v_add_u32 v21, s20, v15
  s_add_u32 s20, s20, 32768
  s_cmp_ge_u32 s20, 163840
  s_cselect_b32 s20, 0, s20
  s_sub_u32 s21, s21, 1
  s_waitcnt lgkmcnt(0)
  v_mfma_f32_32x32x16_bf16 v[64:79], v[160:163], v[168:171], v[64:79]
  s_barrier
  ds_read_b128 v[136:139], v18
  ds_read_b64_tr_b16 v[128:129], v16 offset:0
  ds_read_b64_tr_b16 v[130:131], v16 offset:1024
  v_mfma_f32_32x32x16_bf16 v[80:95], v[160:163], v[172:175], v[80:95]
  ds_read_b128 v[140:143], v18 offset:4096
  ds_read_b64_tr_b16 v[132:133], v17 offset:0
  ds_read_b64_tr_b16 v[134:135], v17 offset:1024
  v_mfma_f32_32x32x16_bf16 v[96:111], v[164:167], v[168:171], v[96:111]
  v_mfma_f32_32x32x16_bf16 v[112:127], v[164:167], v[172:175], v[112:127]
  v_mfma_f32_32x32x16_bf16 v[64:79], v[176:179], v[184:187], v[64:79]
  ds_read_b128 v[152:155], v19
  ds_read_b64_tr_b16 v[144:145], v16 offset:4096
  ds_read_b64_tr_b16 v[146:147], v16 offset:5120
  v_mfma_f32_32x32x16_bf16 v[80:95], v[176:179], v[188:191], v[80:95]
  ds_read_b128 v[156:159], v19 offset:4096
  ds_read_b64_tr_b16 v[148:149], v17 offset:4096
  ds_read_b64_tr_b16 v[150:151], v17 offset:5120
  v_mfma_f32_32x32x16_bf16 v[96:111], v[180:183], v[184:187], v[96:111]
  s_cmp_lg_u32 s21, 0
  v_mfma_f32_32x32x16_bf16 v[112:127], v[180:183], v[188:191], v[112:127]
  s_cbranch_scc1 L_big_loop
  v_mov_b32 v234, 0
  buffer_load_dwordx2 v[232:233], v234, s[68:71], 0 offen sc1
  s_waitcnt lgkmcnt(6)
  v_mfma_f32_32x32x16_bf16 v[64:79], v[128:131], v[136:139], v[64:79]
  ds_read_b128 v[168:171], v20
  ds_read_b64_tr_b16 v[160:161], v16 offset:8192
  ds_read_b64_tr_b16 v[162:163], v16 offset:9216
  v_mfma_f32_32x32x16_bf16 v[80:95], v[128:131], v[140:143], v[80:95]
  ds_read_b128 v[172:175], v20 offset:4096
  ds_read_b64_tr_b16 v[164:165], v17 offset:8192
  ds_read_b64_tr_b16 v[166:167], v17 offset:9216
  v_mfma_f32_32x32x16_bf16 v[96:111], v[132:135], v[136:139], v[96:111]
  v_mfma_f32_32x32x16_bf16 v[112:127], v[132:135], v[140:143], v[112:127]
  s_waitcnt lgkmcnt(6)
  v_mfma_f32_32x32x16_bf16 v[64:79], v[144:147], v[152:155], v[64:79]
  ds_read_b128 v[184:187], v21
  ds_read_b64_tr_b16 v[176:177], v16 offset:12288
  ds_read_b64_tr_b16 v[178:179], v16 offset:13312
  v_mfma_f32_32x32x16_bf16 v[80:95], v[144:147], v[156:159], v[80:95]
  ds_read_b128 v[188:191], v21 offset:4096
  ds_read_b64_tr_b16 v[180:181], v17 offset:12288
  ds_read_b64_tr_b16 v[182:183], v17 offset:13312
  v_mfma_f32_32x32x16_bf16 v[96:111], v[148:151], v[152:155], v[96:111]
  v_mfma_f32_32x32x16_bf16 v[112:127], v[148:151], v[156:159], v[112:127]
  s_cmp_eq_u32 s14, 0
  s_cselect_b32 s22, 0, 0x80008000
  s_waitcnt lgkmcnt(0)
  v_mfma_f32_32x32x16_bf16 v[64:79], v[160:163], v[168:171], v[64:79]
  v_mfma_f32_32x32x16_bf16 v[64:79], v[176:179], v[184:187], v[64:79]
  v_mfma_f32_32x32x16_bf16 v[96:111], v[164:167], v[168:171], v[96:111]
  v_mfma_f32_32x32x16_bf16 v[96:111], v[180:183], v[184:187], v[96:111]
  v_mfma_f32_32x32x16_bf16 v[80:95], v[160:163], v[172:175], v[80:95]
  s_nop 7
  s_nop 1
  v_cvt_pk_bf16_f32 v32, v64, v65
  v_cvt_pk_bf16_f32 v33, v66, v67
  v_cvt_pk_bf16_f32 v34, v68, v69
  v_cvt_pk_bf16_f32 v35, v70, v71
  v_cvt_pk_bf16_f32 v36, v72, v73
  v_cvt_pk_bf16_f32 v37, v74, v75
  v_cvt_pk_bf16_f32 v38, v76, v77
  v_cvt_pk_bf16_f32 v39, v78, v79
  v_xor_b32 v32, s22, v32
  v_xor_b32 v33, s22, v33
  v_xor_b32 v34, s22, v34
  v_xor_b32 v35, s22, v35
  v_mfma_f32_32x32x16_bf16 v[80:95], v[176:179], v[188:191], v[80:95]
  v_xor_b32 v36, s22, v36
  v_xor_b32 v37, s22, v37
  v_xor_b32 v38, s22, v38
  v_xor_b32 v39, s22, v39
  s_nop 1
  v_permlane32_swap_b32 v32, v34
  v_permlane32_swap_b32 v33, v35
  v_permlane32_swap_b32 v36, v38
  v_permlane32_swap_b32 v37, v39
  s_nop 0
  ds_write_b128 v24, v[32:35] offset:0
  ds_write_b128 v25, v[36:39] offset:0
  v_mfma_f32_32x32x16_bf16 v[112:127], v[164:167], v[172:175], v[112:127]
  v_cvt_pk_bf16_f32 v40, v96, v97
  v_cvt_pk_bf16_f32 v41, v98, v99
  v_cvt_pk_bf16_f32 v42, v100, v101
  v_cvt_pk_bf16_f32 v43, v102, v103
  v_cvt_pk_bf16_f32 v44, v104, v105
  v_cvt_pk_bf16_f32 v45, v106, v107
  v_cvt_pk_bf16_f32 v46, v108, v109
  v_cvt_pk_bf16_f32 v47, v110, v111
  v_xor_b32 v40, s22, v40
  v_xor_b32 v41, s22, v41
  v_xor_b32 v42, s22, v42
  v_xor_b32 v43, s22, v43
  v_mfma_f32_32x32x16_bf16 v[112:127], v[180:183], v[188:191], v[112:127]
  v_xor_b32 v44, s22, v44
  v_xor_b32 v45, s22, v45
  v_xor_b32 v46, s22, v46
  v_xor_b32 v47, s22, v47
  s_nop 1
  v_permlane32_swap_b32 v40, v42
  v_permlane32_swap_b32 v41, v43
  v_permlane32_swap_b32 v44, v46
  v_permlane32_swap_b32 v45, v47
  s_nop 0
  ds_write_b128 v26, v[40:43] offset:0
  ds_write_b128 v27, v[44:47] offset:0
  ds_read_b128 v[128:131], v28 offset:0
  ds_read_b128 v[132:135], v28 offset:1024
  ds_read_b128 v[136:139], v28 offset:2048
  ds_read_b128 v[140:143], v28 offset:3072
  v_cvt_pk_bf16_f32 v48, v80, v81
  v_cvt_pk_bf16_f32 v49, v82, v83
  v_cvt_pk_bf16_f32 v50, v84, v85
  v_cvt_pk_bf16_f32 v51, v86, v87
  v_cvt_pk_bf16_f32 v52, v88, v89
  v_cvt_pk_bf16_f32 v53, v90, v91
  v_cvt_pk_bf16_f32 v54, v92, v93
  v_cvt_pk_bf16_f32 v55, v94, v95
  v_xor_b32 v48, s22, v48
  v_xor_b32 v49, s22, v49
  v_xor_b32 v50, s22, v50
  v_xor_b32 v51, s22, v51
  v_xor_b32 v52, s22, v52
  v_xor_b32 v53, s22, v53
  v_xor_b32 v54, s22, v54
  v_xor_b32 v55, s22, v55
  s_nop 1
  v_permlane32_swap_b32 v48, v50
  v_permlane32_swap_b32 v49, v51
  v_permlane32_swap_b32 v52, v54
  v_permlane32_swap_b32 v53, v55
  s_nop 0
  ds_write_b128 v24, v[48:51] offset:4096
  ds_write_b128 v25, v[52:55] offset:4096
  v_cvt_pk_bf16_f32 v56, v112, v113
  v_cvt_pk_bf16_f32 v57, v114, v115
  v_cvt_pk_bf16_f32 v58, v116, v117
  v_cvt_pk_bf16_f32 v59, v118, v119
  v_cvt_pk_bf16_f32 v60, v120, v121
  v_cvt_pk_bf16_f32 v61, v122, v123
  v_cvt_pk_bf16_f32 v62, v124, v125
  v_cvt_pk_bf16_f32 v63, v126, v127
  v_xor_b32 v56, s22, v56
  v_xor_b32 v57, s22, v57
  v_xor_b32 v58, s22, v58
  v_xor_b32 v59, s22, v59
  v_xor_b32 v60, s22, v60
  v_xor_b32 v61, s22, v61
  v_xor_b32 v62, s22, v62
  v_xor_b32 v63, s22, v63
  s_nop 1
  v_permlane32_swap_b32 v56, v58
  v_permlane32_swap_b32 v57, v59
  v_permlane32_swap_b32 v60, v62
  v_permlane32_swap_b32 v61, v63
  s_nop 0
  ds_write_b128 v26, v[56:59] offset:4096
  ds_write_b128 v27, v[60:63] offset:4096
  ds_read_b128 v[144:147], v28 offset:4096
  ds_read_b128 v[148:151], v28 offset:5120
  ds_read_b128 v[152:155], v28 offset:6144
  ds_read_b128 v[156:159], v28 offset:7168
  s_mov_b32 s22, 0
  s_waitcnt lgkmcnt(11)
  buffer_store_dwordx4 v[128:131], v29, s[64:67], s22 offen sc1
  s_add_u32 s22, s22, 16384
  s_waitcnt lgkmcnt(10)
  buffer_store_dwordx4 v[132:135], v29, s[64:67], s22 offen sc1
  s_add_u32 s22, s22, 16384
  s_waitcnt lgkmcnt(9)
  buffer_store_dwordx4 v[136:139], v29, s[64:67], s22 offen sc1
  s_add_u32 s22, s22, 16384
  s_waitcnt lgkmcnt(8)
  buffer_store_dwordx4 v[140:143], v29, s[64:67], s22 offen sc1
  s_add_u32 s22, s22, 16384
  s_waitcnt lgkmcnt(3)
  buffer_store_dwordx4 v[144:147], v29, s[64:67], s22 offen sc1
  s_add_u32 s22, s22, 16384
  s_waitcnt lgkmcnt(2)
  buffer_store_dwordx4 v[148:151], v29, s[64:67], s22 offen sc1
  s_add_u32 s22, s22, 16384
  s_waitcnt lgkmcnt(1)
  buffer_store_dwordx4 v[152:155], v29, s[64:67], s22 offen sc1
  s_add_u32 s22, s22, 16384
  s_waitcnt lgkmcnt(0)
  buffer_store_dwordx4 v[156:159], v29, s[64:67], s22 offen sc1
  s_lshl_b32 s60, s14, 2
  s_add_u32 s60, s60, s16
  s_lshl_b32 s60, s60, 2
  s_add_u32 s60, s60, s3
  s_lshl_b32 s60, s60, 3
  s_mul_i32 s22, s15, 4352
  s_add_u32 s60, s60, s22
  s_add_u32 s60, s60, 8388608
L_nn_3:
  s_waitcnt vmcnt(0)
  v_readfirstlane_b32 s74, v232
  v_readfirstlane_b32 s75, v233
  s_nop 0
  s_cmp_lg_u32 s74, 0
  s_cbranch_scc1 L_nd_4
  buffer_load_dwordx2 v[232:233], v234, s[68:71], 0 offen sc1
  s_branch L_nn_3
L_nd_4:
  v_mov_b32 v230, s74
  v_mov_b32 v231, s75
  v_mov_b32 v234, 0
  s_mov_b64 exec, 1
  buffer_store_dwordx2 v[230:231], v234, s[64:67], s60 offen sc1
  s_mov_b64 exec, -1
  s_barrier
  s_branch L_y_cons
L_partb:
  s_load_dwordx4 s[40:43], s[0:1], 40
  s_and_b32 s12, s2, 7
  s_lshr_b32 s13, s2, 3
  s_sub_u32 s13, s13, 16
  s_lshr_b32 s14, s13, 3
  s_lshl_b32 s12, s12, 1
  s_add_u32 s15, s12, s14
  s_and_b32 s16, s13, 7
  s_lshl_b32 s17, s14, 2
  s_add_u32 s17, s17, s16
  s_and_b32 s17, s17, 7
  s_cmp_ge_u32 s3, 4
  s_cbranch_scc0 L_att_cons
  s_cmp_eq_u32 s3, 7
  s_cbranch_scc1 L_att_pf
  s_sub_u32 s18, s3, 4
  v_lshrrev_b32 v2, 3, v1
  v_and_b32 v3, 7, v1
  v_bfe_u32 v4, v1, 4, 1
  v_lshlrev_b32 v4, 1, v4
  v_xor_b32 v3, v3, v4
  v_xor_b32 v5, 4, v3
  s_mov_b32 s22, 3072
  v_mul_lo_u32 v2, v2, s22
  s_lshl_b32 s19, s16, 7
  s_lshl_b32 s22, s18, 10
  s_add_u32 s19, s19, s22
  v_add_u32 v2, s19, v2
  v_lshl_add_u32 v6, v3, 4, v2
  v_lshl_add_u32 v7, v5, 4, v2
  v_add_u32 v10, 0, v6
  v_add_u32 v11, 23552, v7
  v_add_u32 v12, 47104, v6
  v_add_u32 v13, 70656, v7
  v_add_u32 v14, 98304, v6
  v_add_u32 v15, 121856, v7
  v_add_u32 v16, 145408, v6
  v_add_u32 v17, 168960, v7
  v_lshrrev_b32 v2, 3, v1
  v_and_b32 v3, 7, v1
  v_lshrrev_b32 v4, 4, v1
  v_xor_b32 v3, v3, v4
  v_xor_b32 v5, 4, v3
  s_lshl_b32 s19, s15, 7
  s_sub_u32 s19, s19, 16
  s_mul_i32 s22, s18, 48
  s_add_u32 s19, s19, s22
  v_add_u32 v2, s19, v2
  v_lshlrev_b32 v2, 10, v2
  v_lshl_add_u32 v6, v3, 4, v2
  v_lshl_add_u32 v7, v5, 4, v2
  v_add_u32 v20, 0, v6
  v_add_u32 v21, 8192, v7
  v_add_u32 v22, 16384, v6
  v_add_u32 v23, 24576, v7
  v_add_u32 v24, 32768, v6
  v_add_u32 v25, 40960, v7
  s_mul_i32 s32, s17, 196608
  s_lshl_b32 s33, s17, 7
  s_lshl_b32 s34, s18, 13
  s_mul_i32 s35, s18, 6144
  s_add_u32 s35, s35, 24576
  s_mov_b32 s20, 0
  s_waitcnt lgkmcnt(0)
  s_mov_b32 s24, s42
  s_mov_b32 s25, s43
  s_mov_b32 s26, 1572864
  s_mov_b32 s27, 0x00020000
  s_mov_b32 s28, s40
  s_mov_b32 s29, s41
  s_mov_b32 s30, 2097152
  s_mov_b32 s31, 0x00020000
  s_add_u32 s37, s20, s35
  s_add_u32 m0, s37, 0
  s_nop 0
  buffer_load_dwordx4 v20, s[28:31], s33 offen lds
  s_add_u32 m0, s37, 1024
  s_nop 0
  buffer_load_dwordx4 v21, s[28:31], s33 offen lds
  s_add_u32 m0, s37, 2048
  s_nop 0
  buffer_load_dwordx4 v22, s[28:31], s33 offen lds
  s_add_u32 m0, s37, 3072
  s_nop 0
  buffer_load_dwordx4 v23, s[28:31], s33 offen lds
  s_add_u32 m0, s37, 4096
  s_nop 0
  buffer_load_dwordx4 v24, s[28:31], s33 offen lds
  s_add_u32 m0, s37, 5120
  s_nop 0
  buffer_load_dwordx4 v25, s[28:31], s33 offen lds
  s_add_u32 s37, s20, s34
  s_add_u32 m0, s37, 0
  s_nop 0
  buffer_load_dwordx4 v10, s[24:27], s32 offen offset:0 lds
  buffer_load_dwordx4 v11, s[24:27], s32 offen offset:1024 lds
  buffer_load_dwordx4 v12, s[24:27], s32 offen offset:2048 lds
  buffer_load_dwordx4 v13, s[24:27], s32 offen offset:3072 lds
  s_add_u32 m0, s37, 4096
  s_nop 0
  buffer_load_dwordx4 v14, s[24:27], s32 offen offset:0 lds
  buffer_load_dwordx4 v15, s[24:27], s32 offen offset:1024 lds
  buffer_load_dwordx4 v16, s[24:27], s32 offen offset:2048 lds
  buffer_load_dwordx4 v17, s[24:27], s32 offen offset:3072 lds
  s_add_u32 s32, s32, 196608
  s_cmp_ge_u32 s32, 1572864
  s_cselect_b32 s32, 0, s32
  s_add_u32 s33, s33, 128
  s_and_b32 s33, s33, 0x3ff
  s_add_u32 s20, s20, 43008
  s_cmp_ge_u32 s20, 129024
  s_cselect_b32 s20, 0, s20
  s_add_u32 s37, s20, s35
  s_add_u32 m0, s37, 0
  s_nop 0
  buffer_load_dwordx4 v20, s[28:31], s33 offen lds
  s_add_u32 m0, s37, 1024
  s_nop 0
  buffer_load_dwordx4 v21, s[28:31], s33 offen lds
  s_add_u32 m0, s37, 2048
  s_nop 0
  buffer_load_dwordx4 v22, s[28:31], s33 offen lds
  s_add_u32 m0, s37, 3072
  s_nop 0
  buffer_load_dwordx4 v23, s[28:31], s33 offen lds
  s_add_u32 m0, s37, 4096
  s_nop 0
  buffer_load_dwordx4 v24, s[28:31], s33 offen lds
  s_add_u32 m0, s37, 5120
  s_nop 0
  buffer_load_dwordx4 v25, s[28:31], s33 offen lds
  s_add_u32 s37, s20, s34
  s_add_u32 m0, s37, 0
  s_nop 0
  buffer_load_dwordx4 v10, s[24:27], s32 offen offset:0 lds
  buffer_load_dwordx4 v11, s[24:27], s32 offen offset:1024 lds
  buffer_load_dwordx4 v12, s[24:27], s32 offen offset:2048 lds
  buffer_load_dwordx4 v13, s[24:27], s32 offen offset:3072 lds
  s_add_u32 m0, s37, 4096
  s_nop 0
  buffer_load_dwordx4 v14, s[24:27], s32 offen offset:0 lds
  buffer_load_dwordx4 v15, s[24:27], s32 offen offset:1024 lds
  buffer_load_dwordx4 v16, s[24:27], s32 offen offset:2048 lds
  buffer_load_dwordx4 v17, s[24:27], s32 offen offset:3072 lds
  s_add_u32 s32, s32, 196608
  s_cmp_ge_u32 s32, 1572864
  s_cselect_b32 s32, 0, s32
  s_add_u32 s33, s33, 128
  s_and_b32 s33, s33, 0x3ff
  s_add_u32 s20, s20, 43008
  s_cmp_ge_u32 s20, 129024
  s_cselect_b32 s20, 0, s20
  s_mov_b32 s21, 6
L_att_ld:
  s_waitcnt vmcnt(14)
  s_barrier
  s_add_u32 s37, s20, s35
  s_add_u32 m0, s37, 0
  s_nop 0
  buffer_load_dwordx4 v20, s[28:31], s33 offen lds
  s_add_u32 m0, s37, 1024
  s_nop 0
  buffer_load_dwordx4 v21, s[28:31], s33 offen lds
  s_add_u32 m0, s37, 2048
  s_nop 0
  buffer_load_dwordx4 v22, s[28:31], s33 offen lds
  s_add_u32 m0, s37, 3072
  s_nop 0
  buffer_load_dwordx4 v23, s[28:31], s33 offen lds
  s_add_u32 m0, s37, 4096
  s_nop 0
  buffer_load_dwordx4 v24, s[28:31], s33 offen lds
  s_add_u32 m0, s37, 5120
  s_nop 0
  buffer_load_dwordx4 v25, s[28:31], s33 offen lds
  s_add_u32 s37, s20, s34
  s_add_u32 m0, s37, 0
  s_nop 0
  buffer_load_dwordx4 v10, s[24:27], s32 offen offset:0 lds
  buffer_load_dwordx4 v11, s[24:27], s32 offen offset:1024 lds
  buffer_load_dwordx4 v12, s[24:27], s32 offen offset:2048 lds
  buffer_load_dwordx4 v13, s[24:27], s32 offen offset:3072 lds
  s_add_u32 m0, s37, 4096
  s_nop 0
  buffer_load_dwordx4 v14, s[24:27], s32 offen offset:0 lds
  buffer_load_dwordx4 v15, s[24:27], s32 offen offset:1024 lds
  buffer_load_dwordx4 v16, s[24:27], s32 offen offset:2048 lds
  buffer_load_dwordx4 v17, s[24:27], s32 offen offset:3072 lds
  s_add_u32 s32, s32, 196608
  s_cmp_ge_u32 s32, 1572864
  s_cselect_b32 s32, 0, s32
  s_add_u32 s33, s33, 128
  s_and_b32 s33, s33, 0x3ff
  s_add_u32 s20, s20, 43008
  s_cmp_ge_u32 s20, 129024
  s_cselect_b32 s20, 0, s20
  s_sub_u32 s21, s21, 1
  s_cmp_lg_u32 s21, 0
  s_cbranch_scc1 L_att_ld
  s_waitcnt vmcnt(14)
  s_barrier
  s_waitcnt vmcnt(0)
  s_barrier
L_att_e1:
  s_barrier
  s_sub_u32 s18, s3, 4
  v_lshrrev_b32 v2, 3, v1
  v_and_b32 v3, 7, v1
  v_lshrrev_b32 v4, 4, v1
  v_xor_b32 v3, v3, v4
  v_xor_b32 v5, 4, v3
  s_lshl_b32 s19, s18, 4
  v_add_u32 v2, s19, v2
  s_lshl_b32 s19, s73, 6
  v_add_u32 v6, s19, v2
  v_lshlrev_b32 v6, 10, v6
  v_lshl_add_u32 v200, v3, 4, v6
  v_lshl_add_u32 v201, v5, 4, v6
  v_add_u32 v201, 7168, v201
  s_lshl_b32 s19, s72, 6
  v_add_u32 v6, s19, v2
  s_movk_i32 s19, 2048
  v_mul_lo_u32 v7, v6, s19
  v_lshl_add_u32 v202, v3, 4, v7
  v_lshl_add_u32 v203, v5, 4, v7
  v_add_u32 v203, 15360, v203
  s_lshr_b32 s19, s72, 1
  s_mul_i32 s22, s19, 4352
  s_add_u32 s22, s22, 8388608
  v_and_b32 v3, 31, v1
  v_lshl_add_u32 v208, v3, 3, s22
  s_lshl_b32 s52, s18, 11
  s_sub_u32 s18, s3, 4
  v_lshrrev_b32 v2, 3, v1
  v_and_b32 v3, 7, v1
  v_lshrrev_b32 v4, 4, v1
  v_xor_b32 v3, v3, v4
  v_xor_b32 v5, 4, v3
  s_lshl_b32 s19, s18, 5
  s_lshl_b32 s22, s15, 7
  s_add_u32 s19, s19, s22
  v_add_u32 v6, s19, v2
  s_movk_i32 s19, 1024
  v_mul_lo_u32 v6, v6, s19
  v_add_u32 v6, 5242880, v6
  v_lshl_add_u32 v7, v5, 4, v6
  v_lshl_add_u32 v6, v3, 4, v6
  v_add_u32 v190, 0, v6
  v_add_u32 v191, 7168, v7
  v_add_u32 v192, 14336, v6
  v_add_u32 v193, 21504, v7
  s_lshl_b32 s19, s18, 4
  v_add_u32 v2, s19, v2
  v_and_b32 v3, 7, v1
  v_bfe_u32 v4, v1, 4, 1
  v_lshlrev_b32 v4, 2, v4
  v_xor_b32 v3, v3, v4
  v_lshlrev_b32 v6, 10, v2
  v_lshl_add_u32 v6, v3, 4, v6
  s_lshl_b32 s19, s16, 7
  v_add_u32 v206, s19, v6
  v_add_u32 v207, 7168, v206
  s_mul_i32 s22, s15, 4352
  s_add_u32 s22, s22, 8458240
  v_and_b32 v3, 7, v1
  v_lshl_add_u32 v209, v3, 3, s22
  s_mov_b32 s36, s48
  s_mov_b32 s37, s49
  s_mov_b32 s38, 524288
  s_mov_b32 s39, 0x00020000
  s_barrier
  s_branch L_att_attn
L_att_pf:
  s_bfe_u32 s18, s13, 0x10002
  s_add_u32 s18, s18, s12
  s_lshl_b32 s18, s18, 7
  s_and_b32 s19, s13, 3
  s_lshl_b32 s19, s19, 5
  s_add_u32 s18, s18, s19
  v_lshrrev_b32 v2, 2, v1
  v_add_u32 v2, s18, v2
  v_lshlrev_b32 v2, 12, v2
  v_and_b32 v3, 3, v1
  v_lshl_add_u32 v236, v3, 7, v2
  v_add_u32 v237, 0x10000, v236
  s_lshl_b32 s18, s13, 4
  v_lshrrev_b32 v2, 3, v1
  v_add_u32 v2, s18, v2
  v_lshlrev_b32 v2, 10, v2
  v_and_b32 v3, 7, v1
  v_lshl_add_u32 v238, v3, 7, v2
  v_add_u32 v239, 0x2000, v238
  s_waitcnt lgkmcnt(0)
  s_mov_b32 s24, s4
  s_mov_b32 s25, s5
  s_mov_b32 s26, 2097152
  s_mov_b32 s27, 0x00020000
  s_cmp_eq_u32 s14, 0
  s_cselect_b32 s28, s6, s8
  s_cselect_b32 s29, s7, s9
  s_mov_b32 s30, 8388608
  s_mov_b32 s31, 0x00020000
  s_lshr_b32 s34, s12, 1
  s_mul_i32 s34, s34, 0
  s_add_u32 s33, s34, 0
  s_and_b32 s33, s33, 7
  s_lshl_b32 s32, s33, 18
  buffer_load_dword v244, v238, s[24:27], s32 offen
  s_add_u32 s33, s34, 0
  s_and_b32 s33, s33, 7
  s_lshl_b32 s32, s33, 18
  buffer_load_dword v245, v239, s[24:27], s32 offen
  s_barrier
  s_add_u32 s33, s34, 2
  s_and_b32 s33, s33, 7
  s_lshl_b32 s32, s33, 9
  buffer_load_dword v246, v236, s[28:31], s32 offen
  s_add_u32 s33, s34, 2
  s_and_b32 s33, s33, 7
  s_lshl_b32 s32, s33, 9
  buffer_load_dword v247, v237, s[28:31], s32 offen
  s_barrier
  s_add_u32 s33, s34, 2
  s_and_b32 s33, s33, 7
  s_lshl_b32 s32, s33, 18
  buffer_load_dword v248, v238, s[24:27], s32 offen
  s_add_u32 s33, s34, 2
  s_and_b32 s33, s33, 7
  s_lshl_b32 s32, s33, 18
  buffer_load_dword v249, v239, s[24:27], s32 offen
  s_barrier
  s_add_u32 s33, s34, 3
  s_and_b32 s33, s33, 7
  s_lshl_b32 s32, s33, 9
  buffer_load_dword v250, v236, s[28:31], s32 offen
  s_add_u32 s33, s34, 3
  s_and_b32 s33, s33, 7
  s_lshl_b32 s32, s33, 9
  buffer_load_dword v251, v237, s[28:31], s32 offen
  s_barrier
  s_add_u32 s33, s34, 3
  s_and_b32 s33, s33, 7
  s_lshl_b32 s32, s33, 18
  buffer_load_dword v244, v238, s[24:27], s32 offen
  s_add_u32 s33, s34, 3
  s_and_b32 s33, s33, 7
  s_lshl_b32 s32, s33, 18
  buffer_load_dword v245, v239, s[24:27], s32 offen
  s_barrier
  s_add_u32 s33, s34, 4
  s_and_b32 s33, s33, 7
  s_lshl_b32 s32, s33, 9
  buffer_load_dword v246, v236, s[28:31], s32 offen
  s_add_u32 s33, s34, 4
  s_and_b32 s33, s33, 7
  s_lshl_b32 s32, s33, 9
  buffer_load_dword v247, v237, s[28:31], s32 offen
  s_barrier
  s_add_u32 s33, s34, 4
  s_and_b32 s33, s33, 7
  s_lshl_b32 s32, s33, 18
  buffer_load_dword v248, v238, s[24:27], s32 offen
  s_add_u32 s33, s34, 4
  s_and_b32 s33, s33, 7
  s_lshl_b32 s32, s33, 18
  buffer_load_dword v249, v239, s[24:27], s32 offen
  s_barrier
  s_barrier
  s_add_u32 s33, s34, 5
  s_and_b32 s33, s33, 7
  s_lshl_b32 s32, s33, 9
  buffer_load_dword v250, v236, s[28:31], s32 offen
  s_add_u32 s33, s34, 5
  s_and_b32 s33, s33, 7
  s_lshl_b32 s32, s33, 9
  buffer_load_dword v251, v237, s[28:31], s32 offen
  s_add_u32 s33, s34, 5
  s_and_b32 s33, s33, 7
  s_lshl_b32 s32, s33, 18
  buffer_load_dword v244, v238, s[24:27], s32 offen
  s_add_u32 s33, s34, 5
  s_and_b32 s33, s33, 7
  s_lshl_b32 s32, s33, 18
  buffer_load_dword v245, v239, s[24:27], s32 offen
  s_add_u32 s33, s34, 6
  s_and_b32 s33, s33, 7
  s_lshl_b32 s32, s33, 9
  buffer_load_dword v246, v236, s[28:31], s32 offen
  s_add_u32 s33, s34, 6
  s_and_b32 s33, s33, 7
  s_lshl_b32 s32, s33, 9
  buffer_load_dword v247, v237, s[28:31], s32 offen
  s_add_u32 s33, s34, 6
  s_and_b32 s33, s33, 7
  s_lshl_b32 s32, s33, 18
  buffer_load_dword v248, v238, s[24:27], s32 offen
  s_add_u32 s33, s34, 6
  s_and_b32 s33, s33, 7
  s_lshl_b32 s32, s33, 18
  buffer_load_dword v249, v239, s[24:27], s32 offen
  s_add_u32 s33, s34, 7
  s_and_b32 s33, s33, 7
  s_lshl_b32 s32, s33, 9
  buffer_load_dword v250, v236, s[28:31], s32 offen
  s_add_u32 s33, s34, 7
  s_and_b32 s33, s33, 7
  s_lshl_b32 s32, s33, 9
  buffer_load_dword v251, v237, s[28:31], s32 offen
  s_add_u32 s33, s34, 7
  s_and_b32 s33, s33, 7
  s_lshl_b32 s32, s33, 18
  buffer_load_dword v244, v238, s[24:27], s32 offen
  s_add_u32 s33, s34, 7
  s_and_b32 s33, s33, 7
  s_lshl_b32 s32, s33, 18
  buffer_load_dword v245, v239, s[24:27], s32 offen
  s_branch L_att_e1
L_att_cons:
  v_bfe_u32 v2, v1, 2, 2
  v_and_b32 v3, 3, v1
  v_lshrrev_b32 v4, 4, v1
  v_lshrrev_b32 v5, 1, v2
  v_and_b32 v6, 1, v4
  v_lshl_or_b32 v5, v6, 1, v5
  v_xor_b32 v5, s3, v5
  v_lshlrev_b32 v6, 7, v2
  v_lshl_add_u32 v6, v4, 10, v6
  v_lshl_add_u32 v6, v5, 5, v6
  v_lshl_add_u32 v10, v3, 3, v6
  v_and_b32 v2, 15, v1
  v_lshrrev_b32 v3, 1, v2
  v_xor_b32 v3, v3, v4
  v_lshlrev_b32 v5, 7, v2
  v_add_u32 v5, 24576, v5
  v_xor_b32 v6, 0, v3
  v_lshl_add_u32 v12, v6, 4, v5
  v_xor_b32 v6, 4, v3
  v_lshl_add_u32 v13, v6, 4, v5
  s_mov_b32 s22, 528
  v_mul_lo_u32 v8, v2, s22
  v_lshl_add_u32 v8, v4, 3, v8
  v_lshl_add_u32 v9, v4, 3, v8
  s_lshl_b32 s22, s3, 5
  v_add_u32 v8, s22, v8
  s_lshl_b32 s22, s3, 6
  v_add_u32 v9, s22, v9
  v_mov_b32 v124, 0
  v_mov_b32 v125, 0
  v_mov_b32 v126, 0
  v_mov_b32 v127, 0
  v_mov_b32 v128, 0
  v_mov_b32 v129, 0
  v_mov_b32 v130, 0
  v_mov_b32 v131, 0
  v_mov_b32 v132, 0
  v_mov_b32 v133, 0
  v_mov_b32 v134, 0
  v_mov_b32 v135, 0
  v_mov_b32 v136, 0
  v_mov_b32 v137, 0
  v_mov_b32 v138, 0
  v_mov_b32 v139, 0
  v_mov_b32 v140, 0
  v_mov_b32 v141, 0
  v_mov_b32 v142, 0
  v_mov_b32 v143, 0
  v_mov_b32 v144, 0
  v_mov_b32 v145, 0
  v_mov_b32 v146, 0
  v_mov_b32 v147, 0
  v_mov_b32 v148, 0
  v_mov_b32 v149, 0
  v_mov_b32 v150, 0
  v_mov_b32 v151, 0
  v_mov_b32 v152, 0
  v_mov_b32 v153, 0
  v_mov_b32 v154, 0
  v_mov_b32 v155, 0
  v_mov_b32 v156, 0
  v_mov_b32 v157, 0
  v_mov_b32 v158, 0
  v_mov_b32 v159, 0
  v_mov_b32 v160, 0
  v_mov_b32 v161, 0
  v_mov_b32 v162, 0
  v_mov_b32 v163, 0
  v_mov_b32 v164, 0
  v_mov_b32 v165, 0
  v_mov_b32 v166, 0
  v_mov_b32 v167, 0
  v_mov_b32 v168, 0
  v_mov_b32 v169, 0
  v_mov_b32 v170, 0
  v_mov_b32 v171, 0
  v_mov_b32 v172, 0
  v_mov_b32 v173, 0
  v_mov_b32 v174, 0
  v_mov_b32 v175, 0
  v_mov_b32 v176, 0
  v_mov_b32 v177, 0
  v_mov_b32 v178, 0
  v_mov_b32 v179, 0
  v_mov_b32 v180, 0
  v_mov_b32 v181, 0
  v_mov_b32 v182, 0
  v_mov_b32 v183, 0
  v_mov_b32 v184, 0
  v_mov_b32 v185, 0
  v_mov_b32 v186, 0
  v_mov_b32 v187, 0
  v_mov_b32 v188, 0
  v_mov_b32 v189, 0
  v_mov_b32 v190, 0
  v_mov_b32 v191, 0
  v_mov_b32 v192, 0
  v_mov_b32 v193, 0
  v_mov_b32 v194, 0
  v_mov_b32 v195, 0
  v_mov_b32 v196, 0
  v_mov_b32 v197, 0
  v_mov_b32 v198, 0
  v_mov_b32 v199, 0
  v_mov_b32 v200, 0
  v_mov_b32 v201, 0
  v_mov_b32 v202, 0
  v_mov_b32 v203, 0
  v_mov_b32 v204, 0
  v_mov_b32 v205, 0
  v_mov_b32 v206, 0
  v_mov_b32 v207, 0
  v_mov_b32 v208, 0
  v_mov_b32 v209, 0
  v_mov_b32 v210, 0
  v_mov_b32 v211, 0
  v_mov_b32 v212, 0
  v_mov_b32 v213, 0
  v_mov_b32 v214, 0
  v_mov_b32 v215, 0
  v_mov_b32 v216, 0
  v_mov_b32 v217, 0
  v_mov_b32 v218, 0
  v_mov_b32 v219, 0
  v_mov_b32 v220, 0
  v_mov_b32 v221, 0
  v_mov_b32 v222, 0
  v_mov_b32 v223, 0
  v_mov_b32 v224, 0
  v_mov_b32 v225, 0
  v_mov_b32 v226, 0
  v_mov_b32 v227, 0
  s_mov_b32 s20, 0
  s_waitcnt lgkmcnt(0)
  s_barrier
  v_add_u32 v16, s20, v10
  v_add_u32 v18, s20, v12
  v_add_u32 v19, s20, v13
  s_add_u32 s20, s20, 43008
  s_cmp_ge_u32 s20, 129024
  s_cselect_b32 s20, 0, s20
  ds_read_b64_tr_b16 v[24:25], v16 offset:0
  ds_read_b64_tr_b16 v[26:27], v16 offset:512
  ds_read_b64_tr_b16 v[28:29], v16 offset:8192
  ds_read_b64_tr_b16 v[30:31], v16 offset:8704
  ds_read_b64_tr_b16 v[32:33], v16 offset:16384
  ds_read_b64_tr_b16 v[34:35], v16 offset:16896
  ds_read_b128 v[36:39], v18 offset:0
  ds_read_b128 v[40:43], v18 offset:2048
  ds_read_b128 v[44:47], v18 offset:4096
  ds_read_b128 v[48:51], v18 offset:6144
  ds_read_b128 v[52:55], v18 offset:8192
  ds_read_b128 v[56:59], v18 offset:10240
  ds_read_b128 v[60:63], v18 offset:12288
  ds_read_b128 v[64:67], v18 offset:14336
  ds_read_b128 v[68:71], v18 offset:16384
  s_mov_b32 s21, 8
L_att_loop:
  s_waitcnt lgkmcnt(0)
  v_mfma_f32_16x16x32_bf16 v[156:159], v[28:31], v[36:39], v[156:159]
  ds_read_b64_tr_b16 v[72:73], v16 offset:4096
  v_mfma_f32_16x16x32_bf16 v[192:195], v[32:35], v[36:39], v[192:195]
  ds_read_b64_tr_b16 v[74:75], v16 offset:4608
  v_mfma_f32_16x16x32_bf16 v[124:127], v[24:27], v[40:43], v[124:127]
  ds_read_b64_tr_b16 v[76:77], v16 offset:12288
  v_mfma_f32_16x16x32_bf16 v[160:163], v[28:31], v[40:43], v[160:163]
  ds_read_b64_tr_b16 v[78:79], v16 offset:12800
  v_mfma_f32_16x16x32_bf16 v[196:199], v[32:35], v[40:43], v[196:199]
  ds_read_b64_tr_b16 v[80:81], v16 offset:20480
  v_mfma_f32_16x16x32_bf16 v[128:131], v[24:27], v[44:47], v[128:131]
  ds_read_b64_tr_b16 v[82:83], v16 offset:20992
  v_mfma_f32_16x16x32_bf16 v[164:167], v[28:31], v[44:47], v[164:167]
  ds_read_b128 v[84:87], v19 offset:0
  v_mfma_f32_16x16x32_bf16 v[200:203], v[32:35], v[44:47], v[200:203]
  ds_read_b128 v[88:91], v19 offset:2048
  v_mfma_f32_16x16x32_bf16 v[132:135], v[24:27], v[48:51], v[132:135]
  ds_read_b128 v[92:95], v19 offset:4096
  v_mfma_f32_16x16x32_bf16 v[168:171], v[28:31], v[48:51], v[168:171]
  ds_read_b128 v[96:99], v19 offset:6144
  v_mfma_f32_16x16x32_bf16 v[204:207], v[32:35], v[48:51], v[204:207]
  ds_read_b128 v[100:103], v19 offset:8192
  v_mfma_f32_16x16x32_bf16 v[136:139], v[24:27], v[52:55], v[136:139]
  ds_read_b128 v[104:107], v19 offset:10240
  v_mfma_f32_16x16x32_bf16 v[172:175], v[28:31], v[52:55], v[172:175]
  ds_read_b128 v[108:111], v19 offset:12288
  v_mfma_f32_16x16x32_bf16 v[208:211], v[32:35], v[52:55], v[208:211]
  ds_read_b128 v[112:115], v19 offset:14336
  v_mfma_f32_16x16x32_bf16 v[140:143], v[24:27], v[56:59], v[140:143]
  ds_read_b128 v[116:119], v19 offset:16384
  v_mfma_f32_16x16x32_bf16 v[176:179], v[28:31], v[56:59], v[176:179]
  v_mfma_f32_16x16x32_bf16 v[212:215], v[32:35], v[56:59], v[212:215]
  v_mfma_f32_16x16x32_bf16 v[144:147], v[24:27], v[60:63], v[144:147]
  v_mfma_f32_16x16x32_bf16 v[180:183], v[28:31], v[60:63], v[180:183]
  v_mfma_f32_16x16x32_bf16 v[216:219], v[32:35], v[60:63], v[216:219]
  v_mfma_f32_16x16x32_bf16 v[148:151], v[24:27], v[64:67], v[148:151]
  v_mfma_f32_16x16x32_bf16 v[184:187], v[28:31], v[64:67], v[184:187]
  v_mfma_f32_16x16x32_bf16 v[220:223], v[32:35], v[64:67], v[220:223]
  v_mfma_f32_16x16x32_bf16 v[152:155], v[24:27], v[68:71], v[152:155]
  v_mfma_f32_16x16x32_bf16 v[188:191], v[28:31], v[68:71], v[188:191]
  v_mfma_f32_16x16x32_bf16 v[224:227], v[32:35], v[68:71], v[224:227]
  s_waitcnt lgkmcnt(0)
  s_sub_u32 s21, s21, 1
  s_cmp_eq_u32 s21, 0
  s_cbranch_scc1 L_att_last
  s_barrier
  v_add_u32 v16, s20, v10
  v_add_u32 v18, s20, v12
  v_add_u32 v19, s20, v13
  s_add_u32 s20, s20, 43008
  s_cmp_ge_u32 s20, 129024
  s_cselect_b32 s20, 0, s20
  v_mfma_f32_16x16x32_bf16 v[156:159], v[76:79], v[84:87], v[156:159]
  ds_read_b64_tr_b16 v[24:25], v16 offset:0
  v_mfma_f32_16x16x32_bf16 v[192:195], v[80:83], v[84:87], v[192:195]
  ds_read_b64_tr_b16 v[26:27], v16 offset:512
  v_mfma_f32_16x16x32_bf16 v[124:127], v[72:75], v[88:91], v[124:127]
  ds_read_b64_tr_b16 v[28:29], v16 offset:8192
  v_mfma_f32_16x16x32_bf16 v[160:163], v[76:79], v[88:91], v[160:163]
  ds_read_b64_tr_b16 v[30:31], v16 offset:8704
  v_mfma_f32_16x16x32_bf16 v[196:199], v[80:83], v[88:91], v[196:199]
  ds_read_b64_tr_b16 v[32:33], v16 offset:16384
  v_mfma_f32_16x16x32_bf16 v[128:131], v[72:75], v[92:95], v[128:131]
  ds_read_b64_tr_b16 v[34:35], v16 offset:16896
  v_mfma_f32_16x16x32_bf16 v[164:167], v[76:79], v[92:95], v[164:167]
  ds_read_b128 v[36:39], v18 offset:0
  v_mfma_f32_16x16x32_bf16 v[200:203], v[80:83], v[92:95], v[200:203]
  ds_read_b128 v[40:43], v18 offset:2048
  v_mfma_f32_16x16x32_bf16 v[132:135], v[72:75], v[96:99], v[132:135]
  ds_read_b128 v[44:47], v18 offset:4096
  v_mfma_f32_16x16x32_bf16 v[168:171], v[76:79], v[96:99], v[168:171]
  ds_read_b128 v[48:51], v18 offset:6144
  v_mfma_f32_16x16x32_bf16 v[204:207], v[80:83], v[96:99], v[204:207]
  ds_read_b128 v[52:55], v18 offset:8192
  v_mfma_f32_16x16x32_bf16 v[136:139], v[72:75], v[100:103], v[136:139]
  ds_read_b128 v[56:59], v18 offset:10240
  v_mfma_f32_16x16x32_bf16 v[172:175], v[76:79], v[100:103], v[172:175]
  ds_read_b128 v[60:63], v18 offset:12288
  v_mfma_f32_16x16x32_bf16 v[208:211], v[80:83], v[100:103], v[208:211]
  ds_read_b128 v[64:67], v18 offset:14336
  v_mfma_f32_16x16x32_bf16 v[140:143], v[72:75], v[104:107], v[140:143]
  ds_read_b128 v[68:71], v18 offset:16384
  v_mfma_f32_16x16x32_bf16 v[176:179], v[76:79], v[104:107], v[176:179]
  v_mfma_f32_16x16x32_bf16 v[212:215], v[80:83], v[104:107], v[212:215]
  v_mfma_f32_16x16x32_bf16 v[144:147], v[72:75], v[108:111], v[144:147]
  v_mfma_f32_16x16x32_bf16 v[180:183], v[76:79], v[108:111], v[180:183]
  v_mfma_f32_16x16x32_bf16 v[216:219], v[80:83], v[108:111], v[216:219]
  v_mfma_f32_16x16x32_bf16 v[148:151], v[72:75], v[112:115], v[148:151]
  v_mfma_f32_16x16x32_bf16 v[184:187], v[76:79], v[112:115], v[184:187]
  v_mfma_f32_16x16x32_bf16 v[220:223], v[80:83], v[112:115], v[220:223]
  v_mfma_f32_16x16x32_bf16 v[152:155], v[72:75], v[116:119], v[152:155]
  v_mfma_f32_16x16x32_bf16 v[188:191], v[76:79], v[116:119], v[188:191]
  v_mfma_f32_16x16x32_bf16 v[224:227], v[80:83], v[116:119], v[224:227]
  s_branch L_att_loop
L_att_last:
  s_barrier
  v_add_u32 v6, 33792, v8
  v_add_u32 v7, 33792, v9
  v_mfma_f32_16x16x32_bf16 v[156:159], v[76:79], v[84:87], v[156:159]
  v_mfma_f32_16x16x32_bf16 v[192:195], v[80:83], v[84:87], v[192:195]
  v_mfma_f32_16x16x32_bf16 v[124:127], v[72:75], v[88:91], v[124:127]
  v_mfma_f32_16x16x32_bf16 v[160:163], v[76:79], v[88:91], v[160:163]
  v_mfma_f32_16x16x32_bf16 v[196:199], v[80:83], v[88:91], v[196:199]
  v_mfma_f32_16x16x32_bf16 v[128:131], v[72:75], v[92:95], v[128:131]
  v_mfma_f32_16x16x32_bf16 v[164:167], v[76:79], v[92:95], v[164:167]
  v_mfma_f32_16x16x32_bf16 v[200:203], v[80:83], v[92:95], v[200:203]
  v_mfma_f32_16x16x32_bf16 v[132:135], v[72:75], v[96:99], v[132:135]
  v_mfma_f32_16x16x32_bf16 v[168:171], v[76:79], v[96:99], v[168:171]
  v_cvt_pk_bf16_f32 v24, v156, v157
  v_cvt_pk_bf16_f32 v25, v158, v159
  ds_write_b64 v8, v[24:25] offset:128
  v_mfma_f32_16x16x32_bf16 v[204:207], v[80:83], v[96:99], v[204:207]
  v_cvt_pk_bf16_f32 v26, v192, v193
  v_cvt_pk_bf16_f32 v27, v194, v195
  v_lshlrev_b32 v56, 16, v26
  v_and_b32 v57, 0xffff0000, v26
  v_lshlrev_b32 v58, 16, v27
  v_and_b32 v59, 0xffff0000, v27
  ds_write_b128 v9, v[56:59] offset:256
  v_mfma_f32_16x16x32_bf16 v[136:139], v[72:75], v[100:103], v[136:139]
  v_cvt_pk_bf16_f32 v28, v124, v125
  v_cvt_pk_bf16_f32 v29, v126, v127
  ds_write_b64 v8, v[28:29] offset:8448
  v_mfma_f32_16x16x32_bf16 v[172:175], v[76:79], v[100:103], v[172:175]
  v_cvt_pk_bf16_f32 v30, v160, v161
  v_cvt_pk_bf16_f32 v31, v162, v163
  ds_write_b64 v8, v[30:31] offset:8576
  v_mfma_f32_16x16x32_bf16 v[208:211], v[80:83], v[100:103], v[208:211]
  v_cvt_pk_bf16_f32 v32, v196, v197
  v_cvt_pk_bf16_f32 v33, v198, v199
  v_lshlrev_b32 v60, 16, v32
  v_and_b32 v61, 0xffff0000, v32
  v_lshlrev_b32 v62, 16, v33
  v_and_b32 v63, 0xffff0000, v33
  ds_write_b128 v9, v[60:63] offset:8704
  v_mfma_f32_16x16x32_bf16 v[140:143], v[72:75], v[104:107], v[140:143]
  v_cvt_pk_bf16_f32 v34, v128, v129
  v_cvt_pk_bf16_f32 v35, v130, v131
  ds_write_b64 v8, v[34:35] offset:16896
  v_mfma_f32_16x16x32_bf16 v[176:179], v[76:79], v[104:107], v[176:179]
  v_cvt_pk_bf16_f32 v36, v164, v165
  v_cvt_pk_bf16_f32 v37, v166, v167
  ds_write_b64 v8, v[36:37] offset:17024
  v_mfma_f32_16x16x32_bf16 v[212:215], v[80:83], v[104:107], v[212:215]
  v_cvt_pk_bf16_f32 v38, v200, v201
  v_cvt_pk_bf16_f32 v39, v202, v203
  v_lshlrev_b32 v64, 16, v38
  v_and_b32 v65, 0xffff0000, v38
  v_lshlrev_b32 v66, 16, v39
  v_and_b32 v67, 0xffff0000, v39
  ds_write_b128 v9, v[64:67] offset:17152
  v_mfma_f32_16x16x32_bf16 v[144:147], v[72:75], v[108:111], v[144:147]
  v_cvt_pk_bf16_f32 v40, v132, v133
  v_cvt_pk_bf16_f32 v41, v134, v135
  ds_write_b64 v8, v[40:41] offset:25344
  v_mfma_f32_16x16x32_bf16 v[180:183], v[76:79], v[108:111], v[180:183]
  v_cvt_pk_bf16_f32 v42, v168, v169
  v_cvt_pk_bf16_f32 v43, v170, v171
  ds_write_b64 v8, v[42:43] offset:25472
  v_mfma_f32_16x16x32_bf16 v[216:219], v[80:83], v[108:111], v[216:219]
  v_cvt_pk_bf16_f32 v44, v204, v205
  v_cvt_pk_bf16_f32 v45, v206, v207
  v_lshlrev_b32 v68, 16, v44
  v_and_b32 v69, 0xffff0000, v44
  v_lshlrev_b32 v70, 16, v45
  v_and_b32 v71, 0xffff0000, v45
  ds_write_b128 v9, v[68:71] offset:25600
  v_mfma_f32_16x16x32_bf16 v[148:151], v[72:75], v[112:115], v[148:151]
  v_cvt_pk_bf16_f32 v46, v136, v137
  v_cvt_pk_bf16_f32 v47, v138, v139
  ds_write_b64 v6, v[46:47] offset:0
  v_mfma_f32_16x16x32_bf16 v[184:187], v[76:79], v[112:115], v[184:187]
  v_cvt_pk_bf16_f32 v48, v172, v173
  v_cvt_pk_bf16_f32 v49, v174, v175
  ds_write_b64 v6, v[48:49] offset:128
  v_mfma_f32_16x16x32_bf16 v[220:223], v[80:83], v[112:115], v[220:223]
  v_cvt_pk_bf16_f32 v50, v208, v209
  v_cvt_pk_bf16_f32 v51, v210, v211
  v_lshlrev_b32 v56, 16, v50
  v_and_b32 v57, 0xffff0000, v50
  v_lshlrev_b32 v58, 16, v51
  v_and_b32 v59, 0xffff0000, v51
  ds_write_b128 v7, v[56:59] offset:256
  v_mfma_f32_16x16x32_bf16 v[152:155], v[72:75], v[116:119], v[152:155]
  v_cvt_pk_bf16_f32 v52, v140, v141
  v_cvt_pk_bf16_f32 v53, v142, v143
  ds_write_b64 v6, v[52:53] offset:8448
  v_mfma_f32_16x16x32_bf16 v[188:191], v[76:79], v[116:119], v[188:191]
  v_cvt_pk_bf16_f32 v54, v176, v177
  v_cvt_pk_bf16_f32 v55, v178, v179
  ds_write_b64 v6, v[54:55] offset:8576
  v_mfma_f32_16x16x32_bf16 v[224:227], v[80:83], v[116:119], v[224:227]
  v_cvt_pk_bf16_f32 v24, v212, v213
  v_cvt_pk_bf16_f32 v25, v214, v215
  v_lshlrev_b32 v60, 16, v24
  v_and_b32 v61, 0xffff0000, v24
  v_lshlrev_b32 v62, 16, v25
  v_and_b32 v63, 0xffff0000, v25
  ds_write_b128 v7, v[60:63] offset:8704
  s_nop 7
  v_cvt_pk_bf16_f32 v26, v144, v145
  v_cvt_pk_bf16_f32 v27, v146, v147
  ds_write_b64 v6, v[26:27] offset:16896
  v_cvt_pk_bf16_f32 v28, v180, v181
  v_cvt_pk_bf16_f32 v29, v182, v183
  ds_write_b64 v6, v[28:29] offset:17024
  v_cvt_pk_bf16_f32 v30, v216, v217
  v_cvt_pk_bf16_f32 v31, v218, v219
  v_lshlrev_b32 v64, 16, v30
  v_and_b32 v65, 0xffff0000, v30
  v_lshlrev_b32 v66, 16, v31
  v_and_b32 v67, 0xffff0000, v31
  ds_write_b128 v7, v[64:67] offset:17152
  v_cvt_pk_bf16_f32 v32, v148, v149
  v_cvt_pk_bf16_f32 v33, v150, v151
  ds_write_b64 v6, v[32:33] offset:25344
  v_cvt_pk_bf16_f32 v34, v184, v185
  v_cvt_pk_bf16_f32 v35, v186, v187
  ds_write_b64 v6, v[34:35] offset:25472
  v_cvt_pk_bf16_f32 v36, v220, v221
  v_cvt_pk_bf16_f32 v37, v222, v223
  v_lshlrev_b32 v68, 16, v36
  v_and_b32 v69, 0xffff0000, v36
  v_lshlrev_b32 v70, 16, v37
  v_and_b32 v71, 0xffff0000, v37
  ds_write_b128 v7, v[68:71] offset:25600
  v_cvt_pk_bf16_f32 v38, v152, v153
  v_cvt_pk_bf16_f32 v39, v154, v155
  ds_write_b64 v6, v[38:39] offset:33792
  v_cvt_pk_bf16_f32 v40, v188, v189
  v_cvt_pk_bf16_f32 v41, v190, v191
  ds_write_b64 v6, v[40:41] offset:33920
  v_cvt_pk_bf16_f32 v42, v224, v225
  v_cvt_pk_bf16_f32 v43, v226, v227
  v_lshlrev_b32 v56, 16, v42
  v_and_b32 v57, 0xffff0000, v42
  v_lshlrev_b32 v58, 16, v43
  v_and_b32 v59, 0xffff0000, v43
  ds_write_b128 v7, v[56:59] offset:34048
  s_waitcnt lgkmcnt(0)
  s_barrier
L_att_attn:
  s_mov_b32 s64, s10
  s_mov_b32 s65, s11
  s_mov_b32 s66, 8527872
  s_mov_b32 s67, 0x00020000
  s_mov_b32 s68, s62
  s_mov_b32 s69, s63
  s_mov_b32 s70, 256
  s_mov_b32 s71, 0x00020000
  v_mov_b32 v234, 0
  buffer_load_dwordx2 v[232:233], v234, s[68:71], 0 offen sc1
  s_and_b32 s18, s3, 3
  s_lshr_b32 s19, s3, 2
  s_lshl_b32 s19, s19, 6
  v_add_u32 v2, s19, v1
  s_mov_b32 s22, 528
  v_mul_lo_u32 v3, v2, s22
  s_lshl_b32 s22, s18, 5
  s_add_u32 s22, s22, 1056
  v_add_u32 v3, s22, v3
  ds_read_b128 v[8:11], v3 offset:7392
  ds_read_b128 v[12:15], v3 offset:7408
  ds_read_b128 v[16:19], v3 offset:7520
  ds_read_b128 v[20:23], v3 offset:7536
  ds_read_b128 v[24:27], v3 offset:6464
  ds_read_b128 v[28:31], v3 offset:6480
  ds_read_b128 v[32:35], v3 offset:5408
  ds_read_b128 v[36:39], v3 offset:5424
  ds_read_b128 v[40:43], v3 offset:4352
  ds_read_b128 v[44:47], v3 offset:4368
  ds_read_b128 v[48:51], v3 offset:3296
  ds_read_b128 v[52:55], v3 offset:3312
  ds_read_b128 v[56:59], v3 offset:2240
  ds_read_b128 v[60:63], v3 offset:2256
  ds_read_b128 v[64:67], v3 offset:1184
  ds_read_b128 v[68:71], v3 offset:1200
  ds_read_b128 v[72:75], v3 offset:128
  ds_read_b128 v[76:79], v3 offset:144
  s_lshl_b32 s22, s15, 7
  v_add_u32 v4, s22, v2
  s_waitcnt lgkmcnt(14)
  v_mov_b32 v144, 0
  v_dot2_f32_bf16 v144, v8, v16, v144
  v_dot2_f32_bf16 v144, v9, v17, v144
  v_dot2_f32_bf16 v144, v10, v18, v144
  v_dot2_f32_bf16 v144, v11, v19, v144
  v_dot2_f32_bf16 v144, v12, v20, v144
  v_dot2_f32_bf16 v144, v13, v21, v144
  v_dot2_f32_bf16 v144, v14, v22, v144
  v_dot2_f32_bf16 v144, v15, v23, v144
  s_waitcnt lgkmcnt(12)
  v_mov_b32 v145, 0
  v_dot2_f32_bf16 v145, v8, v24, v145
  v_dot2_f32_bf16 v145, v9, v25, v145
  v_dot2_f32_bf16 v145, v10, v26, v145
  v_dot2_f32_bf16 v145, v11, v27, v145
  v_dot2_f32_bf16 v145, v12, v28, v145
  v_dot2_f32_bf16 v145, v13, v29, v145
  v_dot2_f32_bf16 v145, v14, v30, v145
  v_dot2_f32_bf16 v145, v15, v31, v145
  s_waitcnt lgkmcnt(10)
  v_mov_b32 v146, 0
  v_dot2_f32_bf16 v146, v8, v32, v146
  v_dot2_f32_bf16 v146, v9, v33, v146
  v_dot2_f32_bf16 v146, v10, v34, v146
  v_dot2_f32_bf16 v146, v11, v35, v146
  v_dot2_f32_bf16 v146, v12, v36, v146
  v_dot2_f32_bf16 v146, v13, v37, v146
  v_dot2_f32_bf16 v146, v14, v38, v146
  v_dot2_f32_bf16 v146, v15, v39, v146
  s_waitcnt lgkmcnt(8)
  v_mov_b32 v147, 0
  v_dot2_f32_bf16 v147, v8, v40, v147
  v_dot2_f32_bf16 v147, v9, v41, v147
  v_dot2_f32_bf16 v147, v10, v42, v147
  v_dot2_f32_bf16 v147, v11, v43, v147
  v_dot2_f32_bf16 v147, v12, v44, v147
  v_dot2_f32_bf16 v147, v13, v45, v147
  v_dot2_f32_bf16 v147, v14, v46, v147
  v_dot2_f32_bf16 v147, v15, v47, v147
  s_waitcnt lgkmcnt(6)
  v_mov_b32 v148, 0
  v_dot2_f32_bf16 v148, v8, v48, v148
  v_dot2_f32_bf16 v148, v9, v49, v148
  v_dot2_f32_bf16 v148, v10, v50, v148
  v_dot2_f32_bf16 v148, v11, v51, v148
  v_dot2_f32_bf16 v148, v12, v52, v148
  v_dot2_f32_bf16 v148, v13, v53, v148
  v_dot2_f32_bf16 v148, v14, v54, v148
  v_dot2_f32_bf16 v148, v15, v55, v148
  s_waitcnt lgkmcnt(4)
  v_mov_b32 v149, 0
  v_dot2_f32_bf16 v149, v8, v56, v149
  v_dot2_f32_bf16 v149, v9, v57, v149
  v_dot2_f32_bf16 v149, v10, v58, v149
  v_dot2_f32_bf16 v149, v11, v59, v149
  v_dot2_f32_bf16 v149, v12, v60, v149
  v_dot2_f32_bf16 v149, v13, v61, v149
  v_dot2_f32_bf16 v149, v14, v62, v149
  v_dot2_f32_bf16 v149, v15, v63, v149
  s_waitcnt lgkmcnt(2)
  v_mov_b32 v150, 0
  v_dot2_f32_bf16 v150, v8, v64, v150
  v_dot2_f32_bf16 v150, v9, v65, v150
  v_dot2_f32_bf16 v150, v10, v66, v150
  v_dot2_f32_bf16 v150, v11, v67, v150
  v_dot2_f32_bf16 v150, v12, v68, v150
  v_dot2_f32_bf16 v150, v13, v69, v150
  v_dot2_f32_bf16 v150, v14, v70, v150
  v_dot2_f32_bf16 v150, v15, v71, v150
  s_waitcnt lgkmcnt(0)
  v_mov_b32 v151, 0
  v_dot2_f32_bf16 v151, v8, v72, v151
  v_dot2_f32_bf16 v151, v9, v73, v151
  v_dot2_f32_bf16 v151, v10, v74, v151
  v_dot2_f32_bf16 v151, v11, v75, v151
  v_dot2_f32_bf16 v151, v12, v76, v151
  v_dot2_f32_bf16 v151, v13, v77, v151
  v_dot2_f32_bf16 v151, v14, v78, v151
  v_dot2_f32_bf16 v151, v15, v79, v151
  s_lshl_b32 s22, s18, 5
  v_add_u32 v7, s22, v3
  ds_read_b128 v[80:83], v7 offset:7648
  ds_read_b128 v[84:87], v7 offset:7664
  ds_read_b128 v[88:91], v7 offset:7680
  ds_read_b128 v[92:95], v7 offset:7696
  ds_read_b128 v[96:99], v7 offset:6592
  ds_read_b128 v[100:103], v7 offset:6608
  ds_read_b128 v[104:107], v7 offset:6624
  ds_read_b128 v[108:111], v7 offset:6640
  ds_read_b128 v[112:115], v7 offset:5536
  ds_read_b128 v[116:119], v7 offset:5552
  ds_read_b128 v[120:123], v7 offset:5568
  ds_read_b128 v[124:127], v7 offset:5584
  s_nop 3
  v_cvt_pk_bf16_f32 v180, v144, v145
  v_cvt_pk_bf16_f32 v181, v146, v147
  v_cvt_pk_bf16_f32 v182, v148, v149
  v_cvt_pk_bf16_f32 v183, v150, v151
  v_lshlrev_b32 v144, 16, v180
  v_and_b32 v145, 0xffff0000, v180
  v_lshlrev_b32 v146, 16, v181
  v_and_b32 v147, 0xffff0000, v181
  v_lshlrev_b32 v148, 16, v182
  v_and_b32 v149, 0xffff0000, v182
  v_lshlrev_b32 v150, 16, v183
  v_and_b32 v151, 0xffff0000, v183
  v_mul_f32 v144, 0x3e800000, v144
  v_mul_f32 v145, 0x3e800000, v145
  v_mul_f32 v146, 0x3e800000, v146
  v_mul_f32 v147, 0x3e800000, v147
  v_mul_f32 v148, 0x3e800000, v148
  v_mul_f32 v149, 0x3e800000, v149
  v_mul_f32 v150, 0x3e800000, v150
  v_mul_f32 v151, 0x3e800000, v151
  v_mov_b32 v5, 0xce6e6b28
  v_cmp_gt_u32 vcc, 2, v4
  s_nop 1
  v_cndmask_b32 v145, v145, v5, vcc
  v_cmp_gt_u32 vcc, 4, v4
  s_nop 1
  v_cndmask_b32 v146, v146, v5, vcc
  v_cmp_gt_u32 vcc, 6, v4
  s_nop 1
  v_cndmask_b32 v147, v147, v5, vcc
  v_cmp_gt_u32 vcc, 8, v4
  s_nop 1
  v_cndmask_b32 v148, v148, v5, vcc
  v_cmp_gt_u32 vcc, 10, v4
  s_nop 1
  v_cndmask_b32 v149, v149, v5, vcc
  v_cmp_gt_u32 vcc, 12, v4
  s_nop 1
  v_cndmask_b32 v150, v150, v5, vcc
  v_cmp_gt_u32 vcc, 14, v4
  s_nop 1
  v_cndmask_b32 v151, v151, v5, vcc
  v_max3_f32 v6, v144, v145, v146
  v_max3_f32 v6, v6, v147, v148
  v_max3_f32 v6, v6, v149, v150
  v_max_f32 v6, v6, v151
  s_mov_b32 s22, 0x3fb8aa3b
  v_sub_f32 v144, v144, v6
  v_sub_f32 v145, v145, v6
  v_sub_f32 v146, v146, v6
  v_sub_f32 v147, v147, v6
  v_sub_f32 v148, v148, v6
  v_sub_f32 v149, v149, v6
  v_sub_f32 v150, v150, v6
  v_sub_f32 v151, v151, v6
  v_mul_f32 v144, s22, v144
  v_mul_f32 v145, s22, v145
  v_mul_f32 v146, s22, v146
  v_mul_f32 v147, s22, v147
  v_mul_f32 v148, s22, v148
  v_mul_f32 v149, s22, v149
  v_mul_f32 v150, s22, v150
  v_mul_f32 v151, s22, v151
  v_exp_f32 v144, v144
  v_exp_f32 v145, v145
  v_exp_f32 v146, v146
  v_exp_f32 v147, v147
  v_exp_f32 v148, v148
  v_exp_f32 v149, v149
  v_exp_f32 v150, v150
  v_exp_f32 v151, v151
  s_nop 0
  v_add_f32 v6, v144, v145
  v_add_f32 v6, v6, v146
  v_add_f32 v6, v6, v147
  v_add_f32 v6, v6, v148
  v_add_f32 v6, v6, v149
  v_add_f32 v6, v6, v150
  v_add_f32 v6, v6, v151
  v_rcp_f32 v6, v6
  s_nop 0
  v_mul_f32 v144, v144, v6
  v_mul_f32 v145, v145, v6
  v_mul_f32 v146, v146, v6
  v_mul_f32 v147, v147, v6
  v_mul_f32 v148, v148, v6
  v_mul_f32 v149, v149, v6
  v_mul_f32 v150, v150, v6
  v_mul_f32 v151, v151, v6
  v_cvt_pk_bf16_f32 v180, v144, v145
  v_cvt_pk_bf16_f32 v181, v146, v147
  v_cvt_pk_bf16_f32 v182, v148, v149
  v_cvt_pk_bf16_f32 v183, v150, v151
  v_lshlrev_b32 v144, 16, v180
  v_and_b32 v145, 0xffff0000, v180
  v_lshlrev_b32 v146, 16, v181
  v_and_b32 v147, 0xffff0000, v181
  v_lshlrev_b32 v148, 16, v182
  v_and_b32 v149, 0xffff0000, v182
  v_lshlrev_b32 v150, 16, v183
  v_and_b32 v151, 0xffff0000, v183
  s_waitcnt lgkmcnt(8)
  ds_read_b128 v[128:131], v7 offset:4480
  ds_read_b128 v[132:135], v7 offset:4496
  ds_read_b128 v[136:139], v7 offset:4512
  ds_read_b128 v[140:143], v7 offset:4528
  v_pk_mul_f32 v[160:161], v[144:145], v[80:81] op_sel:[0,0] op_sel_hi:[0,1]
  v_pk_mul_f32 v[162:163], v[144:145], v[82:83] op_sel:[0,0] op_sel_hi:[0,1]
  v_pk_mul_f32 v[164:165], v[144:145], v[84:85] op_sel:[0,0] op_sel_hi:[0,1]
  v_pk_mul_f32 v[166:167], v[144:145], v[86:87] op_sel:[0,0] op_sel_hi:[0,1]
  v_pk_mul_f32 v[168:169], v[144:145], v[88:89] op_sel:[0,0] op_sel_hi:[0,1]
  v_pk_mul_f32 v[170:171], v[144:145], v[90:91] op_sel:[0,0] op_sel_hi:[0,1]
  v_pk_mul_f32 v[172:173], v[144:145], v[92:93] op_sel:[0,0] op_sel_hi:[0,1]
  v_pk_mul_f32 v[174:175], v[144:145], v[94:95] op_sel:[0,0] op_sel_hi:[0,1]
  s_waitcnt lgkmcnt(8)
  ds_read_b128 v[16:19], v7 offset:3424
  ds_read_b128 v[20:23], v7 offset:3440
  ds_read_b128 v[24:27], v7 offset:3456
  ds_read_b128 v[28:31], v7 offset:3472
  v_pk_fma_f32 v[160:161], v[144:145], v[96:97], v[160:161] op_sel:[1,0,0] op_sel_hi:[1,1,1]
  v_pk_fma_f32 v[162:163], v[144:145], v[98:99], v[162:163] op_sel:[1,0,0] op_sel_hi:[1,1,1]
  v_pk_fma_f32 v[164:165], v[144:145], v[100:101], v[164:165] op_sel:[1,0,0] op_sel_hi:[1,1,1]
  v_pk_fma_f32 v[166:167], v[144:145], v[102:103], v[166:167] op_sel:[1,0,0] op_sel_hi:[1,1,1]
  v_pk_fma_f32 v[168:169], v[144:145], v[104:105], v[168:169] op_sel:[1,0,0] op_sel_hi:[1,1,1]
  v_pk_fma_f32 v[170:171], v[144:145], v[106:107], v[170:171] op_sel:[1,0,0] op_sel_hi:[1,1,1]
  v_pk_fma_f32 v[172:173], v[144:145], v[108:109], v[172:173] op_sel:[1,0,0] op_sel_hi:[1,1,1]
  v_pk_fma_f32 v[174:175], v[144:145], v[110:111], v[174:175] op_sel:[1,0,0] op_sel_hi:[1,1,1]
  s_waitcnt lgkmcnt(8)
  ds_read_b128 v[32:35], v7 offset:2368
  ds_read_b128 v[36:39], v7 offset:2384
  ds_read_b128 v[40:43], v7 offset:2400
  ds_read_b128 v[44:47], v7 offset:2416
  v_pk_fma_f32 v[160:161], v[146:147], v[112:113], v[160:161] op_sel:[0,0,0] op_sel_hi:[0,1,1]
  v_pk_fma_f32 v[162:163], v[146:147], v[114:115], v[162:163] op_sel:[0,0,0] op_sel_hi:[0,1,1]
  v_pk_fma_f32 v[164:165], v[146:147], v[116:117], v[164:165] op_sel:[0,0,0] op_sel_hi:[0,1,1]
  v_pk_fma_f32 v[166:167], v[146:147], v[118:119], v[166:167] op_sel:[0,0,0] op_sel_hi:[0,1,1]
  v_pk_fma_f32 v[168:169], v[146:147], v[120:121], v[168:169] op_sel:[0,0,0] op_sel_hi:[0,1,1]
  v_pk_fma_f32 v[170:171], v[146:147], v[122:123], v[170:171] op_sel:[0,0,0] op_sel_hi:[0,1,1]
  v_pk_fma_f32 v[172:173], v[146:147], v[124:125], v[172:173] op_sel:[0,0,0] op_sel_hi:[0,1,1]
  v_pk_fma_f32 v[174:175], v[146:147], v[126:127], v[174:175] op_sel:[0,0,0] op_sel_hi:[0,1,1]
  s_waitcnt lgkmcnt(8)
  ds_read_b128 v[48:51], v7 offset:1312
  ds_read_b128 v[52:55], v7 offset:1328
  ds_read_b128 v[56:59], v7 offset:1344
  ds_read_b128 v[60:63], v7 offset:1360
  v_pk_fma_f32 v[160:161], v[146:147], v[128:129], v[160:161] op_sel:[1,0,0] op_sel_hi:[1,1,1]
  v_pk_fma_f32 v[162:163], v[146:147], v[130:131], v[162:163] op_sel:[1,0,0] op_sel_hi:[1,1,1]
  v_pk_fma_f32 v[164:165], v[146:147], v[132:133], v[164:165] op_sel:[1,0,0] op_sel_hi:[1,1,1]
  v_pk_fma_f32 v[166:167], v[146:147], v[134:135], v[166:167] op_sel:[1,0,0] op_sel_hi:[1,1,1]
  v_pk_fma_f32 v[168:169], v[146:147], v[136:137], v[168:169] op_sel:[1,0,0] op_sel_hi:[1,1,1]
  v_pk_fma_f32 v[170:171], v[146:147], v[138:139], v[170:171] op_sel:[1,0,0] op_sel_hi:[1,1,1]
  v_pk_fma_f32 v[172:173], v[146:147], v[140:141], v[172:173] op_sel:[1,0,0] op_sel_hi:[1,1,1]
  v_pk_fma_f32 v[174:175], v[146:147], v[142:143], v[174:175] op_sel:[1,0,0] op_sel_hi:[1,1,1]
  s_waitcnt lgkmcnt(8)
  ds_read_b128 v[64:67], v7 offset:256
  ds_read_b128 v[68:71], v7 offset:272
  ds_read_b128 v[72:75], v7 offset:288
  ds_read_b128 v[76:79], v7 offset:304
  v_pk_fma_f32 v[160:161], v[148:149], v[16:17], v[160:161] op_sel:[0,0,0] op_sel_hi:[0,1,1]
  v_pk_fma_f32 v[162:163], v[148:149], v[18:19], v[162:163] op_sel:[0,0,0] op_sel_hi:[0,1,1]
  v_pk_fma_f32 v[164:165], v[148:149], v[20:21], v[164:165] op_sel:[0,0,0] op_sel_hi:[0,1,1]
  v_pk_fma_f32 v[166:167], v[148:149], v[22:23], v[166:167] op_sel:[0,0,0] op_sel_hi:[0,1,1]
  v_pk_fma_f32 v[168:169], v[148:149], v[24:25], v[168:169] op_sel:[0,0,0] op_sel_hi:[0,1,1]
  v_pk_fma_f32 v[170:171], v[148:149], v[26:27], v[170:171] op_sel:[0,0,0] op_sel_hi:[0,1,1]
  v_pk_fma_f32 v[172:173], v[148:149], v[28:29], v[172:173] op_sel:[0,0,0] op_sel_hi:[0,1,1]
  v_pk_fma_f32 v[174:175], v[148:149], v[30:31], v[174:175] op_sel:[0,0,0] op_sel_hi:[0,1,1]
  s_waitcnt lgkmcnt(8)
  v_pk_fma_f32 v[160:161], v[148:149], v[32:33], v[160:161] op_sel:[1,0,0] op_sel_hi:[1,1,1]
  v_pk_fma_f32 v[162:163], v[148:149], v[34:35], v[162:163] op_sel:[1,0,0] op_sel_hi:[1,1,1]
  v_pk_fma_f32 v[164:165], v[148:149], v[36:37], v[164:165] op_sel:[1,0,0] op_sel_hi:[1,1,1]
  v_pk_fma_f32 v[166:167], v[148:149], v[38:39], v[166:167] op_sel:[1,0,0] op_sel_hi:[1,1,1]
  v_pk_fma_f32 v[168:169], v[148:149], v[40:41], v[168:169] op_sel:[1,0,0] op_sel_hi:[1,1,1]
  v_pk_fma_f32 v[170:171], v[148:149], v[42:43], v[170:171] op_sel:[1,0,0] op_sel_hi:[1,1,1]
  v_pk_fma_f32 v[172:173], v[148:149], v[44:45], v[172:173] op_sel:[1,0,0] op_sel_hi:[1,1,1]
  v_pk_fma_f32 v[174:175], v[148:149], v[46:47], v[174:175] op_sel:[1,0,0] op_sel_hi:[1,1,1]
  s_waitcnt lgkmcnt(4)
  v_pk_fma_f32 v[160:161], v[150:151], v[48:49], v[160:161] op_sel:[0,0,0] op_sel_hi:[0,1,1]
  v_pk_fma_f32 v[162:163], v[150:151], v[50:51], v[162:163] op_sel:[0,0,0] op_sel_hi:[0,1,1]
  v_pk_fma_f32 v[164:165], v[150:151], v[52:53], v[164:165] op_sel:[0,0,0] op_sel_hi:[0,1,1]
  v_pk_fma_f32 v[166:167], v[150:151], v[54:55], v[166:167] op_sel:[0,0,0] op_sel_hi:[0,1,1]
  v_pk_fma_f32 v[168:169], v[150:151], v[56:57], v[168:169] op_sel:[0,0,0] op_sel_hi:[0,1,1]
  v_pk_fma_f32 v[170:171], v[150:151], v[58:59], v[170:171] op_sel:[0,0,0] op_sel_hi:[0,1,1]
  v_pk_fma_f32 v[172:173], v[150:151], v[60:61], v[172:173] op_sel:[0,0,0] op_sel_hi:[0,1,1]
  v_pk_fma_f32 v[174:175], v[150:151], v[62:63], v[174:175] op_sel:[0,0,0] op_sel_hi:[0,1,1]
  s_waitcnt lgkmcnt(0)
  v_pk_fma_f32 v[160:161], v[150:151], v[64:65], v[160:161] op_sel:[1,0,0] op_sel_hi:[1,1,1]
  v_pk_fma_f32 v[162:163], v[150:151], v[66:67], v[162:163] op_sel:[1,0,0] op_sel_hi:[1,1,1]
  v_pk_fma_f32 v[164:165], v[150:151], v[68:69], v[164:165] op_sel:[1,0,0] op_sel_hi:[1,1,1]
  v_pk_fma_f32 v[166:167], v[150:151], v[70:71], v[166:167] op_sel:[1,0,0] op_sel_hi:[1,1,1]
  v_pk_fma_f32 v[168:169], v[150:151], v[72:73], v[168:169] op_sel:[1,0,0] op_sel_hi:[1,1,1]
  v_pk_fma_f32 v[170:171], v[150:151], v[74:75], v[170:171] op_sel:[1,0,0] op_sel_hi:[1,1,1]
  v_pk_fma_f32 v[172:173], v[150:151], v[76:77], v[172:173] op_sel:[1,0,0] op_sel_hi:[1,1,1]
  v_pk_fma_f32 v[174:175], v[150:151], v[78:79], v[174:175] op_sel:[1,0,0] op_sel_hi:[1,1,1]
  v_cvt_pk_bf16_f32 v180, v160, v161
  v_cvt_pk_bf16_f32 v181, v162, v163
  v_cvt_pk_bf16_f32 v182, v164, v165
  v_cvt_pk_bf16_f32 v183, v166, v167
  v_cvt_pk_bf16_f32 v184, v168, v169
  v_cvt_pk_bf16_f32 v185, v170, v171
  v_cvt_pk_bf16_f32 v186, v172, v173
  v_cvt_pk_bf16_f32 v187, v174, v175
  s_movk_i32 s22, 144
  v_mul_lo_u32 v3, v2, s22
  s_lshl_b32 s22, s18, 5
  s_add_u32 s22, s22, 131072
  v_add_u32 v3, s22, v3
  ds_write_b128 v3, v[180:183]
  ds_write_b128 v3, v[184:187] offset:16
  v_lshrrev_b32 v2, 3, v1
  s_lshl_b32 s22, s3, 4
  v_add_u32 v2, s22, v2
  v_and_b32 v3, 7, v1
  s_movk_i32 s22, 144
  v_mul_lo_u32 v4, v2, s22
  v_lshl_add_u32 v4, v3, 4, v4
  v_add_u32 v4, 131072, v4
  s_lshl_b32 s22, s15, 7
  v_add_u32 v2, s22, v2
  s_movk_i32 s22, 1024
  v_mul_lo_u32 v2, v2, s22
  v_lshl_add_u32 v2, v3, 4, v2
  s_lshl_b32 s22, s16, 7
  s_add_u32 s22, s22, 5242880
  s_add_u32 s23, s22, 8192
  s_waitcnt lgkmcnt(0)
  s_barrier
  ds_read_b128 v[8:11], v4
  ds_read_b128 v[12:15], v4 offset:1152
  s_waitcnt lgkmcnt(1)
  buffer_store_dwordx4 v[8:11], v2, s[64:67], s22 offen sc1
  s_waitcnt lgkmcnt(0)
  buffer_store_dwordx4 v[12:15], v2, s[64:67], s23 offen sc1
  s_lshl_b32 s60, s16, 3
  s_mul_i32 s22, s15, 4352
  s_add_u32 s60, s60, s22
  s_add_u32 s60, s60, 8458240
  s_mov_b32 s61, 0
L_nn_5:
  s_waitcnt vmcnt(0)
  v_readfirstlane_b32 s74, v232
  v_readfirstlane_b32 s75, v233
  s_nop 0
  s_cmp_lg_u32 s74, 0
  s_cbranch_scc1 L_nd_6
  buffer_load_dwordx2 v[232:233], v234, s[68:71], 0 offen sc1
  s_branch L_nn_5
L_nd_6:
  s_barrier
  s_cmp_ge_u32 s3, 4
  s_cbranch_scc0 L_op_cons
  s_lshl_b32 s54, s52, 1
  s_cmp_lg_u32 s3, 4
  s_cbranch_scc1 L_op_nofl
  v_mov_b32 v230, s74
  v_mov_b32 v231, s75
  v_mov_b32 v234, 0
  s_mov_b64 exec, 1
  buffer_store_dwordx2 v[230:231], v234, s[64:67], s60 offen sc1
  s_mov_b64 exec, -1
L_op_nofl:
  s_mov_b32 s36, s48
  s_mov_b32 s37, s49
  s_mov_b32 s38, 524288
  s_mov_b32 s39, 0x00020000
  s_add_u32 s53, s17, 0
  s_and_b32 s53, s53, 7
  s_lshl_b32 s53, s53, 16
  s_add_u32 m0, s52, 65536
  s_nop 0
  buffer_load_dwordx4 v206, s[36:39], s53 offen lds
  buffer_load_dwordx4 v207, s[36:39], s53 offen offset:1024 lds
  s_add_u32 s53, s17, 1
  s_and_b32 s53, s53, 7
  s_lshl_b32 s53, s53, 16
  s_add_u32 m0, s52, 73728
  s_nop 0
  buffer_load_dwordx4 v206, s[36:39], s53 offen lds
  buffer_load_dwordx4 v207, s[36:39], s53 offen offset:1024 lds
  s_add_u32 s53, s17, 2
  s_and_b32 s53, s53, 7
  s_lshl_b32 s53, s53, 16
  s_add_u32 m0, s52, 81920
  s_nop 0
  buffer_load_dwordx4 v206, s[36:39], s53 offen lds
  buffer_load_dwordx4 v207, s[36:39], s53 offen offset:1024 lds
  s_add_u32 s53, s17, 3
  s_and_b32 s53, s53, 7
  s_lshl_b32 s53, s53, 16
  s_add_u32 m0, s52, 90112
  s_nop 0
  buffer_load_dwordx4 v206, s[36:39], s53 offen lds
  buffer_load_dwordx4 v207, s[36:39], s53 offen offset:1024 lds
  s_add_u32 s53, s17, 4
  s_and_b32 s53, s53, 7
  s_lshl_b32 s53, s53, 16
  s_add_u32 m0, s52, 98304
  s_nop 0
  buffer_load_dwordx4 v206, s[36:39], s53 offen lds
  buffer_load_dwordx4 v207, s[36:39], s53 offen offset:1024 lds
  s_add_u32 s53, s17, 5
  s_and_b32 s53, s53, 7
  s_lshl_b32 s53, s53, 16
  s_add_u32 m0, s52, 106496
  s_nop 0
  buffer_load_dwordx4 v206, s[36:39], s53 offen lds
  buffer_load_dwordx4 v207, s[36:39], s53 offen offset:1024 lds
  s_add_u32 s53, s17, 6
  s_and_b32 s53, s53, 7
  s_lshl_b32 s53, s53, 16
  s_add_u32 m0, s52, 114688
  s_nop 0
  buffer_load_dwordx4 v206, s[36:39], s53 offen lds
  buffer_load_dwordx4 v207, s[36:39], s53 offen offset:1024 lds
  s_add_u32 s53, s17, 7
  s_and_b32 s53, s53, 7
  s_lshl_b32 s53, s53, 16
  s_add_u32 m0, s52, 122880
  s_nop 0
  buffer_load_dwordx4 v206, s[36:39], s53 offen lds
  buffer_load_dwordx4 v207, s[36:39], s53 offen offset:1024 lds
  s_cmp_lg_u32 s3, 4
  s_cbranch_scc1 L_op_nopoll
  s_branch L_poll0_8
L_poll_7:
  s_sleep 2
L_poll0_8:
  buffer_load_dwordx2 v[228:229], v209, s[64:67], 0 offen sc1
  s_waitcnt vmcnt(0)
  v_cmp_eq_u32 s[76:77], s74, v228
  v_cmp_eq_u32 s[78:79], s75, v229
  s_nop 1
  s_and_b64 s[76:77], s[76:77], s[78:79]
  s_cmp_eq_u64 s[76:77], -1
  s_cbranch_scc0 L_poll_7
L_op_nopoll:
  s_waitcnt vmcnt(0)
  s_barrier
  s_add_u32 s53, s17, 0
  s_and_b32 s53, s53, 7
  s_lshl_b32 s53, s53, 7
  s_add_u32 m0, s54, 0
  s_nop 0
  buffer_load_dwordx4 v190, s[64:67], s53 offen offset:0 lds
  buffer_load_dwordx4 v191, s[64:67], s53 offen offset:1024 lds
  buffer_load_dwordx4 v192, s[64:67], s53 offen offset:2048 lds
  buffer_load_dwordx4 v193, s[64:67], s53 offen offset:3072 lds
  s_add_u32 s53, s17, 1
  s_and_b32 s53, s53, 7
  s_lshl_b32 s53, s53, 7
  s_add_u32 m0, s54, 16384
  s_nop 0
  buffer_load_dwordx4 v190, s[64:67], s53 offen offset:0 lds
  buffer_load_dwordx4 v191, s[64:67], s53 offen offset:1024 lds
  buffer_load_dwordx4 v192, s[64:67], s53 offen offset:2048 lds
  buffer_load_dwordx4 v193, s[64:67], s53 offen offset:3072 lds
  s_add_u32 s53, s17, 2
  s_and_b32 s53, s53, 7
  s_lshl_b32 s53, s53, 7
  s_add_u32 m0, s54, 32768
  s_nop 0
  buffer_load_dwordx4 v190, s[64:67], s53 offen offset:0 lds
  buffer_load_dwordx4 v191, s[64:67], s53 offen offset:1024 lds
  buffer_load_dwordx4 v192, s[64:67], s53 offen offset:2048 lds
  buffer_load_dwordx4 v193, s[64:67], s53 offen offset:3072 lds
  s_add_u32 s53, s17, 3
  s_and_b32 s53, s53, 7
  s_lshl_b32 s53, s53, 7
  s_add_u32 m0, s54, 49152
  s_nop 0
  buffer_load_dwordx4 v190, s[64:67], s53 offen offset:0 lds
  buffer_load_dwordx4 v191, s[64:67], s53 offen offset:1024 lds
  buffer_load_dwordx4 v192, s[64:67], s53 offen offset:2048 lds
  buffer_load_dwordx4 v193, s[64:67], s53 offen offset:3072 lds
  s_waitcnt vmcnt(12)
  s_barrier
  s_waitcnt vmcnt(8)
  s_barrier
  s_add_u32 s53, s17, 4
  s_and_b32 s53, s53, 7
  s_lshl_b32 s53, s53, 7
  s_add_u32 m0, s54, 0
  s_nop 0
  buffer_load_dwordx4 v190, s[64:67], s53 offen offset:0 lds
  buffer_load_dwordx4 v191, s[64:67], s53 offen offset:1024 lds
  buffer_load_dwordx4 v192, s[64:67], s53 offen offset:2048 lds
  buffer_load_dwordx4 v193, s[64:67], s53 offen offset:3072 lds
  s_lshl_b32 s53, s88, 1
  s_add_u32 s53, s53, 4
  s_bitcmp1_b32 s53, 3
  s_cselect_b32 s56, s46, s44
  s_cselect_b32 s57, s47, s45
  s_and_b32 s53, s53, 7
  s_lshl_b32 s53, s53, 7
  s_add_u32 m0, s52, 65536
  s_nop 0
  buffer_load_dwordx4 v200, s[56:59], s53 offen lds
  buffer_load_dwordx4 v201, s[56:59], s53 offen offset:1024 lds
  s_waitcnt vmcnt(10)
  s_barrier
  s_add_u32 s53, s17, 5
  s_and_b32 s53, s53, 7
  s_lshl_b32 s53, s53, 7
  s_add_u32 m0, s54, 16384
  s_nop 0
  buffer_load_dwordx4 v190, s[64:67], s53 offen offset:0 lds
  buffer_load_dwordx4 v191, s[64:67], s53 offen offset:1024 lds
  buffer_load_dwordx4 v192, s[64:67], s53 offen offset:2048 lds
  buffer_load_dwordx4 v193, s[64:67], s53 offen offset:3072 lds
  s_lshl_b32 s53, s88, 1
  s_add_u32 s53, s53, 5
  s_bitcmp1_b32 s53, 3
  s_cselect_b32 s56, s46, s44
  s_cselect_b32 s57, s47, s45
  s_and_b32 s53, s53, 7
  s_lshl_b32 s53, s53, 7
  s_add_u32 m0, s52, 73728
  s_nop 0
  buffer_load_dwordx4 v200, s[56:59], s53 offen lds
  buffer_load_dwordx4 v201, s[56:59], s53 offen offset:1024 lds
  s_waitcnt vmcnt(12)
  s_barrier
  s_add_u32 s53, s17, 6
  s_and_b32 s53, s53, 7
  s_lshl_b32 s53, s53, 7
  s_add_u32 m0, s54, 32768
  s_nop 0
  buffer_load_dwordx4 v190, s[64:67], s53 offen offset:0 lds
  buffer_load_dwordx4 v191, s[64:67], s53 offen offset:1024 lds
  buffer_load_dwordx4 v192, s[64:67], s53 offen offset:2048 lds
  buffer_load_dwordx4 v193, s[64:67], s53 offen offset:3072 lds
  s_lshl_b32 s53, s88, 1
  s_add_u32 s53, s53, 6
  s_bitcmp1_b32 s53, 3
  s_cselect_b32 s56, s46, s44
  s_cselect_b32 s57, s47, s45
  s_and_b32 s53, s53, 7
  s_lshl_b32 s53, s53, 7
  s_add_u32 m0, s52, 81920
  s_nop 0
  buffer_load_dwordx4 v200, s[56:59], s53 offen lds
  buffer_load_dwordx4 v201, s[56:59], s53 offen offset:1024 lds
  s_waitcnt vmcnt(14)
  s_barrier
  s_add_u32 s53, s17, 7
  s_and_b32 s53, s53, 7
  s_lshl_b32 s53, s53, 7
  s_add_u32 m0, s54, 49152
  s_nop 0
  buffer_load_dwordx4 v190, s[64:67], s53 offen offset:0 lds
  buffer_load_dwordx4 v191, s[64:67], s53 offen offset:1024 lds
  buffer_load_dwordx4 v192, s[64:67], s53 offen offset:2048 lds
  buffer_load_dwordx4 v193, s[64:67], s53 offen offset:3072 lds
  s_lshl_b32 s53, s88, 1
  s_add_u32 s53, s53, 7
  s_bitcmp1_b32 s53, 3
  s_cselect_b32 s56, s46, s44
  s_cselect_b32 s57, s47, s45
  s_and_b32 s53, s53, 7
  s_lshl_b32 s53, s53, 7
  s_add_u32 m0, s52, 90112
  s_nop 0
  buffer_load_dwordx4 v200, s[56:59], s53 offen lds
  buffer_load_dwordx4 v201, s[56:59], s53 offen offset:1024 lds
  s_waitcnt vmcnt(14)
  s_barrier
  s_lshl_b32 s53, s88, 1
  s_add_u32 s53, s53, 8
  s_bitcmp1_b32 s53, 3
  s_cselect_b32 s56, s46, s44
  s_cselect_b32 s57, s47, s45
  s_and_b32 s53, s53, 7
  s_lshl_b32 s53, s53, 7
  s_add_u32 m0, s52, 98304
  s_nop 0
  buffer_load_dwordx4 v200, s[56:59], s53 offen lds
  buffer_load_dwordx4 v201, s[56:59], s53 offen offset:1024 lds
  s_lshl_b32 s53, s88, 1
  s_add_u32 s53, s53, 0
  s_bitcmp1_b32 s53, 3
  s_cselect_b32 s56, s46, s44
  s_cselect_b32 s57, s47, s45
  s_and_b32 s53, s53, 7
  s_lshl_b32 s53, s53, 7
  s_add_u32 m0, s52, 0
  s_nop 0
  buffer_load_dwordx4 v200, s[56:59], s53 offen lds
  buffer_load_dwordx4 v201, s[56:59], s53 offen offset:1024 lds
  s_lshl_b32 s53, s88, 1
  s_add_u32 s53, s53, 1
  s_bitcmp1_b32 s53, 3
  s_cselect_b32 s56, s46, s44
  s_cselect_b32 s57, s47, s45
  s_and_b32 s53, s53, 7
  s_lshl_b32 s53, s53, 7
  s_add_u32 m0, s52, 8192
  s_nop 0
  buffer_load_dwordx4 v200, s[56:59], s53 offen lds
  buffer_load_dwordx4 v201, s[56:59], s53 offen offset:1024 lds
  s_waitcnt vmcnt(14)
  s_barrier
  s_lshl_b32 s53, s88, 1
  s_add_u32 s53, s53, 9
  s_bitcmp1_b32 s53, 3
  s_cselect_b32 s56, s46, s44
  s_cselect_b32 s57, s47, s45
  s_and_b32 s53, s53, 7
  s_lshl_b32 s53, s53, 7
  s_add_u32 m0, s52, 106496
  s_nop 0
  buffer_load_dwordx4 v200, s[56:59], s53 offen lds
  buffer_load_dwordx4 v201, s[56:59], s53 offen offset:1024 lds
  s_lshl_b32 s53, s88, 1
  s_add_u32 s53, s53, 2
  s_bitcmp1_b32 s53, 3
  s_cselect_b32 s56, s46, s44
  s_cselect_b32 s57, s47, s45
  s_and_b32 s53, s53, 7
  s_lshl_b32 s53, s53, 7
  s_add_u32 m0, s52, 16384
  s_nop 0
  buffer_load_dwordx4 v200, s[56:59], s53 offen lds
  buffer_load_dwordx4 v201, s[56:59], s53 offen offset:1024 lds
  s_lshl_b32 s53, s88, 1
  s_add_u32 s53, s53, 3
  s_bitcmp1_b32 s53, 3
  s_cselect_b32 s56, s46, s44
  s_cselect_b32 s57, s47, s45
  s_and_b32 s53, s53, 7
  s_lshl_b32 s53, s53, 7
  s_add_u32 m0, s52, 24576
  s_nop 0
  buffer_load_dwordx4 v200, s[56:59], s53 offen lds
  buffer_load_dwordx4 v201, s[56:59], s53 offen offset:1024 lds
  s_waitcnt vmcnt(14)
  s_barrier
  s_lshl_b32 s53, s88, 1
  s_add_u32 s53, s53, 10
  s_bitcmp1_b32 s53, 3
  s_cselect_b32 s56, s46, s44
  s_cselect_b32 s57, s47, s45
  s_and_b32 s53, s53, 7
  s_lshl_b32 s53, s53, 7
  s_add_u32 m0, s52, 114688
  s_nop 0
  buffer_load_dwordx4 v200, s[56:59], s53 offen lds
  buffer_load_dwordx4 v201, s[56:59], s53 offen offset:1024 lds
  s_barrier
  s_lshl_b32 s53, s88, 1
  s_add_u32 s53, s53, 11
  s_bitcmp1_b32 s53, 3
  s_cselect_b32 s56, s46, s44
  s_cselect_b32 s57, s47, s45
  s_and_b32 s53, s53, 7
  s_lshl_b32 s53, s53, 7
  s_add_u32 m0, s52, 122880
  s_nop 0
  buffer_load_dwordx4 v200, s[56:59], s53 offen lds
  buffer_load_dwordx4 v201, s[56:59], s53 offen offset:1024 lds
  s_waitcnt vmcnt(0)
  s_barrier
  s_branch L_y_loader
L_op_cons:
  s_and_b32 s18, s3, 1
  s_lshr_b32 s19, s3, 1
  v_and_b32 v2, 31, v1
  v_bfe_u32 v3, v2, 1, 3
  v_lshrrev_b32 v5, 5, v1
  v_xor_b32 v3, v3, v5
  v_lshlrev_b32 v4, 7, v2
  s_lshl_b32 s22, s18, 12
  s_lshl_b32 s23, s19, 12
  v_xor_b32 v6, 0, v3
  v_lshl_add_u32 v6, v6, 4, v4
  v_add_u32 v212, s22, v6
  v_add_u32 v220, s23, v6
  v_add_u32 v216, 0x10000, v212
  v_add_u32 v224, 0x20000, v220
  v_xor_b32 v6, 2, v3
  v_lshl_add_u32 v6, v6, 4, v4
  v_add_u32 v213, s22, v6
  v_add_u32 v221, s23, v6
  v_add_u32 v217, 0x10000, v213
  v_add_u32 v225, 0x20000, v221
  v_xor_b32 v6, 4, v3
  v_lshl_add_u32 v6, v6, 4, v4
  v_add_u32 v214, s22, v6
  v_add_u32 v222, s23, v6
  v_add_u32 v218, 0x10000, v214
  v_add_u32 v226, 0x20000, v222
  v_xor_b32 v6, 6, v3
  v_lshl_add_u32 v6, v6, 4, v4
  v_add_u32 v215, s22, v6
  v_add_u32 v223, s23, v6
  v_add_u32 v219, 0x10000, v215
  v_add_u32 v227, 0x20000, v223
  s_lshl_b32 s22, s72, 6
  s_lshl_b32 s23, s19, 5
  s_add_u32 s22, s22, s23
  v_add_u32 v6, s22, v2
  v_lshlrev_b32 v6, 11, v6
  v_lshl_add_u32 v6, v5, 4, v6
  s_lshl_b32 s22, s73, 7
  s_lshl_b32 s23, s18, 6
  s_add_u32 s22, s22, s23
  v_add_u32 v238, s22, v6
  v_bfe_u32 v2, v1, 2, 2
  v_and_b32 v3, 3, v1
  v_bfe_u32 v4, v1, 4, 1
  v_lshlrev_b32 v6, 7, v2
  v_lshl_add_u32 v6, v5, 10, v6
  v_lshl_add_u32 v6, v4, 5, v6
  v_lshl_add_u32 v6, v3, 3, v6
  v_lshrrev_b32 v7, 1, v2
  v_xor_b32 v7, s18, v7
  v_lshl_add_u32 v236, v7, 6, v6
  v_add_u32 v237, 0x20000, v236
  s_lshl_b32 s22, s19, 12
  v_add_u32 v150, s22, v220
  v_add_u32 v151, s22, v221
  v_add_u32 v152, s22, v222
  v_add_u32 v153, s22, v223
  v_add_u32 v154, 0x10000, v236
  v_and_b32 v2, 31, v1
  s_lshl_b32 s22, s15, 7
  s_lshl_b32 s23, s19, 6
  s_add_u32 s22, s22, s23
  v_add_u32 v2, s22, v2
  v_lshlrev_b32 v2, 11, v2
  v_lshrrev_b32 v3, 5, v1
  v_lshl_add_u32 v2, v3, 4, v2
  s_lshl_b32 s22, s16, 7
  s_lshl_b32 s23, s18, 6
  s_add_u32 s22, s22, s23
  v_add_u32 v155, s22, v2
  v_add_u32 v156, 0x10000, v155
  s_mov_b32 s24, s50
  s_mov_b32 s25, s51
  s_mov_b32 s26, 4194304
  s_mov_b32 s27, 0x00020000
  s_barrier
  s_barrier
  ds_read_b64_tr_b16 v[52:53], v154 offset:0
  ds_read_b64_tr_b16 v[54:55], v154 offset:512
  ds_read_b128 v[68:71], v150 offset:0
  ds_read_b128 v[72:75], v150 offset:4096
  ds_read_b64_tr_b16 v[56:57], v154 offset:2048
  ds_read_b64_tr_b16 v[58:59], v154 offset:2560
  ds_read_b128 v[76:79], v151 offset:0
  ds_read_b128 v[80:83], v151 offset:4096
  ds_read_b64_tr_b16 v[60:61], v154 offset:4096
  ds_read_b64_tr_b16 v[62:63], v154 offset:4608
  ds_read_b128 v[84:87], v152 offset:0
  ds_read_b128 v[88:91], v152 offset:4096
  ds_read_b64_tr_b16 v[64:65], v154 offset:6144
  ds_read_b64_tr_b16 v[66:67], v154 offset:6656
  ds_read_b128 v[92:95], v153 offset:0
  ds_read_b128 v[96:99], v153 offset:4096
  s_waitcnt lgkmcnt(0)
  s_barrier
  v_mfma_f32_32x32x16_bf16 v[20:35], v[52:55], v[68:71], 0
  ds_read_b64_tr_b16 v[100:101], v154 offset:8192
  ds_read_b64_tr_b16 v[102:103], v154 offset:8704
  ds_read_b128 v[116:119], v150 offset:16384
  v_mfma_f32_32x32x16_bf16 v[36:51], v[52:55], v[72:75], 0
  ds_read_b128 v[120:123], v150 offset:20480
  ds_read_b64_tr_b16 v[104:105], v154 offset:10240
  ds_read_b64_tr_b16 v[106:107], v154 offset:10752
  v_mfma_f32_32x32x16_bf16 v[20:35], v[56:59], v[76:79], v[20:35]
  ds_read_b128 v[124:127], v151 offset:16384
  ds_read_b128 v[128:131], v151 offset:20480
  ds_read_b64_tr_b16 v[108:109], v154 offset:12288
  v_mfma_f32_32x32x16_bf16 v[36:51], v[56:59], v[80:83], v[36:51]
  ds_read_b64_tr_b16 v[110:111], v154 offset:12800
  ds_read_b128 v[132:135], v152 offset:16384
  ds_read_b128 v[136:139], v152 offset:20480
  v_mfma_f32_32x32x16_bf16 v[20:35], v[60:63], v[84:87], v[20:35]
  ds_read_b64_tr_b16 v[112:113], v154 offset:14336
  ds_read_b64_tr_b16 v[114:115], v154 offset:14848
  ds_read_b128 v[140:143], v153 offset:16384
  v_mfma_f32_32x32x16_bf16 v[36:51], v[60:63], v[88:91], v[36:51]
  ds_read_b128 v[144:147], v153 offset:20480
  v_mfma_f32_32x32x16_bf16 v[20:35], v[64:67], v[92:95], v[20:35]
  v_mfma_f32_32x32x16_bf16 v[36:51], v[64:67], v[96:99], v[36:51]
  s_waitcnt lgkmcnt(0)
  s_barrier
  v_mfma_f32_32x32x16_bf16 v[20:35], v[100:103], v[116:119], v[20:35]
  ds_read_b64_tr_b16 v[52:53], v154 offset:16384
  ds_read_b64_tr_b16 v[54:55], v154 offset:16896
  ds_read_b128 v[68:71], v150 offset:32768
  v_mfma_f32_32x32x16_bf16 v[36:51], v[100:103], v[120:123], v[36:51]
  ds_read_b128 v[72:75], v150 offset:36864
  ds_read_b64_tr_b16 v[56:57], v154 offset:18432
  ds_read_b64_tr_b16 v[58:59], v154 offset:18944
  v_mfma_f32_32x32x16_bf16 v[20:35], v[104:107], v[124:127], v[20:35]
  ds_read_b128 v[76:79], v151 offset:32768
  ds_read_b128 v[80:83], v151 offset:36864
  ds_read_b64_tr_b16 v[60:61], v154 offset:20480
  v_mfma_f32_32x32x16_bf16 v[36:51], v[104:107], v[128:131], v[36:51]
  ds_read_b64_tr_b16 v[62:63], v154 offset:20992
  ds_read_b128 v[84:87], v152 offset:32768
  ds_read_b128 v[88:91], v152 offset:36864
  v_mfma_f32_32x32x16_bf16 v[20:35], v[108:111], v[132:135], v[20:35]
  ds_read_b64_tr_b16 v[64:65], v154 offset:22528
  ds_read_b64_tr_b16 v[66:67], v154 offset:23040
  ds_read_b128 v[92:95], v153 offset:32768
  v_mfma_f32_32x32x16_bf16 v[36:51], v[108:111], v[136:139], v[36:51]
  ds_read_b128 v[96:99], v153 offset:36864
  v_mfma_f32_32x32x16_bf16 v[20:35], v[112:115], v[140:143], v[20:35]
  v_mfma_f32_32x32x16_bf16 v[36:51], v[112:115], v[144:147], v[36:51]
  s_waitcnt lgkmcnt(0)
  s_barrier
  v_mfma_f32_32x32x16_bf16 v[20:35], v[52:55], v[68:71], v[20:35]
  ds_read_b64_tr_b16 v[100:101], v154 offset:24576
  ds_read_b64_tr_b16 v[102:103], v154 offset:25088
  ds_read_b128 v[116:119], v150 offset:49152
  v_mfma_f32_32x32x16_bf16 v[36:51], v[52:55], v[72:75], v[36:51]
  ds_read_b128 v[120:123], v150 offset:53248
  ds_read_b64_tr_b16 v[104:105], v154 offset:26624
  ds_read_b64_tr_b16 v[106:107], v154 offset:27136
  v_mfma_f32_32x32x16_bf16 v[20:35], v[56:59], v[76:79], v[20:35]
  ds_read_b128 v[124:127], v151 offset:49152
  ds_read_b128 v[128:131], v151 offset:53248
  ds_read_b64_tr_b16 v[108:109], v154 offset:28672
  v_mfma_f32_32x32x16_bf16 v[36:51], v[56:59], v[80:83], v[36:51]
  ds_read_b64_tr_b16 v[110:111], v154 offset:29184
  ds_read_b128 v[132:135], v152 offset:49152
  ds_read_b128 v[136:139], v152 offset:53248
  v_mfma_f32_32x32x16_bf16 v[20:35], v[60:63], v[84:87], v[20:35]
  ds_read_b64_tr_b16 v[112:113], v154 offset:30720
  ds_read_b64_tr_b16 v[114:115], v154 offset:31232
  ds_read_b128 v[140:143], v153 offset:49152
  v_mfma_f32_32x32x16_bf16 v[36:51], v[60:63], v[88:91], v[36:51]
  ds_read_b128 v[144:147], v153 offset:53248
  v_mfma_f32_32x32x16_bf16 v[20:35], v[64:67], v[92:95], v[20:35]
  v_mfma_f32_32x32x16_bf16 v[36:51], v[64:67], v[96:99], v[36:51]
  s_waitcnt lgkmcnt(0)
  s_barrier
  v_mfma_f32_32x32x16_bf16 v[20:35], v[100:103], v[116:119], v[20:35]
  ds_read_b64_tr_b16 v[52:53], v154 offset:32768
  ds_read_b64_tr_b16 v[54:55], v154 offset:33280
  ds_read_b128 v[68:71], v150 offset:0
  v_mfma_f32_32x32x16_bf16 v[36:51], v[100:103], v[120:123], v[36:51]
  ds_read_b128 v[72:75], v150 offset:4096
  ds_read_b64_tr_b16 v[56:57], v154 offset:34816
  ds_read_b64_tr_b16 v[58:59], v154 offset:35328
  v_mfma_f32_32x32x16_bf16 v[20:35], v[104:107], v[124:127], v[20:35]
  ds_read_b128 v[76:79], v151 offset:0
  ds_read_b128 v[80:83], v151 offset:4096
  ds_read_b64_tr_b16 v[60:61], v154 offset:36864
  v_mfma_f32_32x32x16_bf16 v[36:51], v[104:107], v[128:131], v[36:51]
  ds_read_b64_tr_b16 v[62:63], v154 offset:37376
  ds_read_b128 v[84:87], v152 offset:0
  ds_read_b128 v[88:91], v152 offset:4096
  v_mfma_f32_32x32x16_bf16 v[20:35], v[108:111], v[132:135], v[20:35]
  ds_read_b64_tr_b16 v[64:65], v154 offset:38912
  ds_read_b64_tr_b16 v[66:67], v154 offset:39424
  ds_read_b128 v[92:95], v153 offset:0
  v_mfma_f32_32x32x16_bf16 v[36:51], v[108:111], v[136:139], v[36:51]
  ds_read_b128 v[96:99], v153 offset:4096
  v_mfma_f32_32x32x16_bf16 v[20:35], v[112:115], v[140:143], v[20:35]
  v_mfma_f32_32x32x16_bf16 v[36:51], v[112:115], v[144:147], v[36:51]
  s_waitcnt lgkmcnt(0)
  s_barrier
  v_mfma_f32_32x32x16_bf16 v[20:35], v[52:55], v[68:71], v[20:35]
  ds_read_b64_tr_b16 v[100:101], v154 offset:40960
  ds_read_b64_tr_b16 v[102:103], v154 offset:41472
  ds_read_b128 v[116:119], v150 offset:16384
  v_mfma_f32_32x32x16_bf16 v[36:51], v[52:55], v[72:75], v[36:51]
  ds_read_b128 v[120:123], v150 offset:20480
  ds_read_b64_tr_b16 v[104:105], v154 offset:43008
  ds_read_b64_tr_b16 v[106:107], v154 offset:43520
  v_mfma_f32_32x32x16_bf16 v[20:35], v[56:59], v[76:79], v[20:35]
  ds_read_b128 v[124:127], v151 offset:16384
  ds_read_b128 v[128:131], v151 offset:20480
  ds_read_b64_tr_b16 v[108:109], v154 offset:45056
  v_mfma_f32_32x32x16_bf16 v[36:51], v[56:59], v[80:83], v[36:51]
  ds_read_b64_tr_b16 v[110:111], v154 offset:45568
  ds_read_b128 v[132:135], v152 offset:16384
  ds_read_b128 v[136:139], v152 offset:20480
  v_mfma_f32_32x32x16_bf16 v[20:35], v[60:63], v[84:87], v[20:35]
  ds_read_b64_tr_b16 v[112:113], v154 offset:47104
  ds_read_b64_tr_b16 v[114:115], v154 offset:47616
  ds_read_b128 v[140:143], v153 offset:16384
  v_mfma_f32_32x32x16_bf16 v[36:51], v[60:63], v[88:91], v[36:51]
  ds_read_b128 v[144:147], v153 offset:20480
  v_mfma_f32_32x32x16_bf16 v[20:35], v[64:67], v[92:95], v[20:35]
  v_mfma_f32_32x32x16_bf16 v[36:51], v[64:67], v[96:99], v[36:51]
  s_waitcnt lgkmcnt(0)
  s_barrier
  v_mfma_f32_32x32x16_bf16 v[20:35], v[100:103], v[116:119], v[20:35]
  ds_read_b64_tr_b16 v[52:53], v154 offset:49152
  ds_read_b64_tr_b16 v[54:55], v154 offset:49664
  ds_read_b128 v[68:71], v150 offset:32768
  v_mfma_f32_32x32x16_bf16 v[36:51], v[100:103], v[120:123], v[36:51]
  ds_read_b128 v[72:75], v150 offset:36864
  ds_read_b64_tr_b16 v[56:57], v154 offset:51200
  ds_read_b64_tr_b16 v[58:59], v154 offset:51712
  v_mfma_f32_32x32x16_bf16 v[20:35], v[104:107], v[124:127], v[20:35]
  ds_read_b128 v[76:79], v151 offset:32768
  ds_read_b128 v[80:83], v151 offset:36864
  ds_read_b64_tr_b16 v[60:61], v154 offset:53248
  v_mfma_f32_32x32x16_bf16 v[36:51], v[104:107], v[128:131], v[36:51]
  ds_read_b64_tr_b16 v[62:63], v154 offset:53760
  ds_read_b128 v[84:87], v152 offset:32768
  ds_read_b128 v[88:91], v152 offset:36864
  v_mfma_f32_32x32x16_bf16 v[20:35], v[108:111], v[132:135], v[20:35]
  ds_read_b64_tr_b16 v[64:65], v154 offset:55296
  ds_read_b64_tr_b16 v[66:67], v154 offset:55808
  ds_read_b128 v[92:95], v153 offset:32768
  v_mfma_f32_32x32x16_bf16 v[36:51], v[108:111], v[136:139], v[36:51]
  ds_read_b128 v[96:99], v153 offset:36864
  v_mfma_f32_32x32x16_bf16 v[20:35], v[112:115], v[140:143], v[20:35]
  v_mfma_f32_32x32x16_bf16 v[36:51], v[112:115], v[144:147], v[36:51]
  s_waitcnt lgkmcnt(0)
  s_barrier
  v_mfma_f32_32x32x16_bf16 v[20:35], v[52:55], v[68:71], v[20:35]
  ds_read_b64_tr_b16 v[100:101], v154 offset:57344
  ds_read_b64_tr_b16 v[102:103], v154 offset:57856
  ds_read_b128 v[116:119], v150 offset:49152
  v_mfma_f32_32x32x16_bf16 v[36:51], v[52:55], v[72:75], v[36:51]
  ds_read_b128 v[120:123], v150 offset:53248
  ds_read_b64_tr_b16 v[104:105], v154 offset:59392
  ds_read_b64_tr_b16 v[106:107], v154 offset:59904
  v_mfma_f32_32x32x16_bf16 v[20:35], v[56:59], v[76:79], v[20:35]
  ds_read_b128 v[124:127], v151 offset:49152
  ds_read_b128 v[128:131], v151 offset:53248
  ds_read_b64_tr_b16 v[108:109], v154 offset:61440
  v_mfma_f32_32x32x16_bf16 v[36:51], v[56:59], v[80:83], v[36:51]
  ds_read_b64_tr_b16 v[110:111], v154 offset:61952
  ds_read_b128 v[132:135], v152 offset:49152
  ds_read_b128 v[136:139], v152 offset:53248
  v_mfma_f32_32x32x16_bf16 v[20:35], v[60:63], v[84:87], v[20:35]
  ds_read_b64_tr_b16 v[112:113], v154 offset:63488
  ds_read_b64_tr_b16 v[114:115], v154 offset:64000
  ds_read_b128 v[140:143], v153 offset:49152
  v_mfma_f32_32x32x16_bf16 v[36:51], v[60:63], v[88:91], v[36:51]
  ds_read_b128 v[144:147], v153 offset:53248
  v_mfma_f32_32x32x16_bf16 v[20:35], v[64:67], v[92:95], v[20:35]
  v_mfma_f32_32x32x16_bf16 v[36:51], v[64:67], v[96:99], v[36:51]
  s_waitcnt lgkmcnt(0)
  s_barrier
  v_mfma_f32_32x32x16_bf16 v[20:35], v[100:103], v[116:119], v[20:35]
  v_mfma_f32_32x32x16_bf16 v[36:51], v[100:103], v[120:123], v[36:51]
  v_mfma_f32_32x32x16_bf16 v[20:35], v[104:107], v[124:127], v[20:35]
  v_mfma_f32_32x32x16_bf16 v[36:51], v[104:107], v[128:131], v[36:51]
  v_mfma_f32_32x32x16_bf16 v[20:35], v[108:111], v[132:135], v[20:35]
  v_mfma_f32_32x32x16_bf16 v[36:51], v[108:111], v[136:139], v[36:51]
  v_mfma_f32_32x32x16_bf16 v[20:35], v[112:115], v[140:143], v[20:35]
  v_mfma_f32_32x32x16_bf16 v[36:51], v[112:115], v[144:147], v[36:51]
  v_and_b32 v2, 31, v1
  v_and_b32 v3, 7, v2
  v_lshrrev_b32 v4, 5, v1
  v_xor_b32 v3, v3, v4
  s_lshl_b32 s22, s18, 2
  v_xor_b32 v3, s22, v3
  v_lshlrev_b32 v4, 7, v2
  s_lshl_b32 s22, s19, 13
  s_add_u32 s22, s22, 32768
  v_add_u32 v4, s22, v4
  v_lshl_add_u32 v5, v3, 4, v4
  v_xor_b32 v3, 2, v3
  v_lshl_add_u32 v6, v3, 4, v4
  v_lshrrev_b32 v2, 3, v1
  v_and_b32 v3, 7, v1
  v_xor_b32 v4, v3, v2
  v_lshlrev_b32 v7, 7, v2
  v_lshl_add_u32 v7, v4, 4, v7
  s_lshl_b32 s22, s3, 12
  s_add_u32 s22, s22, 32768
  v_add_u32 v7, s22, v7
  s_lshl_b32 s22, s15, 7
  s_lshl_b32 s23, s3, 5
  s_add_u32 s22, s22, s23
  v_add_u32 v2, s22, v2
  v_lshlrev_b32 v2, 11, v2
  v_lshl_add_u32 v2, v3, 4, v2
  v_cvt_pk_bf16_f32 v52, v20, v21
  v_cvt_pk_bf16_f32 v53, v22, v23
  v_cvt_pk_bf16_f32 v54, v24, v25
  v_cvt_pk_bf16_f32 v55, v26, v27
  v_cvt_pk_bf16_f32 v56, v28, v29
  v_cvt_pk_bf16_f32 v57, v30, v31
  v_cvt_pk_bf16_f32 v58, v32, v33
  v_cvt_pk_bf16_f32 v59, v34, v35
  s_nop 1
  v_permlane32_swap_b32 v52, v54
  v_permlane32_swap_b32 v53, v55
  v_permlane32_swap_b32 v56, v58
  v_permlane32_swap_b32 v57, v59
  s_nop 0
  ds_write_b128 v5, v[52:55] offset:0
  ds_write_b128 v6, v[56:59] offset:0
  v_cvt_pk_bf16_f32 v60, v36, v37
  v_cvt_pk_bf16_f32 v61, v38, v39
  v_cvt_pk_bf16_f32 v62, v40, v41
  v_cvt_pk_bf16_f32 v63, v42, v43
  v_cvt_pk_bf16_f32 v64, v44, v45
  v_cvt_pk_bf16_f32 v65, v46, v47
  v_cvt_pk_bf16_f32 v66, v48, v49
  v_cvt_pk_bf16_f32 v67, v50, v51
  s_nop 1
  v_permlane32_swap_b32 v60, v62
  v_permlane32_swap_b32 v61, v63
  v_permlane32_swap_b32 v64, v66
  v_permlane32_swap_b32 v65, v67
  s_nop 0
  ds_write_b128 v5, v[60:63] offset:4096
  ds_write_b128 v6, v[64:67] offset:4096
  s_waitcnt lgkmcnt(0)
  s_barrier
  ds_read_b128 v[52:55], v7 offset:0
  ds_read_b128 v[56:59], v7 offset:1024
  ds_read_b128 v[60:63], v7 offset:2048
  ds_read_b128 v[64:67], v7 offset:3072
  s_lshl_b32 s22, s16, 7
  s_add_u32 s22, s22, 1024
  s_waitcnt lgkmcnt(3)
  buffer_store_dwordx4 v[52:55], v2, s[24:27], s22 offen
  s_add_u32 s22, s22, 16384
  s_waitcnt lgkmcnt(2)
  buffer_store_dwordx4 v[56:59], v2, s[24:27], s22 offen
  s_add_u32 s22, s22, 16384
  s_waitcnt lgkmcnt(1)
  buffer_store_dwordx4 v[60:63], v2, s[24:27], s22 offen
  s_add_u32 s22, s22, 16384
  s_waitcnt lgkmcnt(0)
  buffer_store_dwordx4 v[64:67], v2, s[24:27], s22 offen
  s_branch L_y_cons
L_y_loader:
  s_add_u32 s54, s52, 8192
  s_barrier
  s_lshl_b32 s53, s88, 1
  s_add_u32 s53, s53, 12
  s_bitcmp1_b32 s53, 3
  s_cselect_b32 s56, s46, s44
  s_cselect_b32 s57, s47, s45
  s_and_b32 s53, s53, 7
  s_lshl_b32 s53, s53, 7
  s_add_u32 m0, s52, 0
  s_nop 0
  buffer_load_dwordx4 v200, s[56:59], s53 offen lds
  buffer_load_dwordx4 v201, s[56:59], s53 offen offset:1024 lds
  s_lshl_b32 s53, s88, 1
  s_add_u32 s53, s53, 13
  s_bitcmp1_b32 s53, 3
  s_cselect_b32 s56, s46, s44
  s_cselect_b32 s57, s47, s45
  s_and_b32 s53, s53, 7
  s_lshl_b32 s53, s53, 7
  s_add_u32 m0, s52, 8192
  s_nop 0
  buffer_load_dwordx4 v200, s[56:59], s53 offen lds
  buffer_load_dwordx4 v201, s[56:59], s53 offen offset:1024 lds
  s_lshl_b32 s53, s88, 1
  s_add_u32 s53, s53, 14
  s_bitcmp1_b32 s53, 3
  s_cselect_b32 s56, s46, s44
  s_cselect_b32 s57, s47, s45
  s_and_b32 s53, s53, 7
  s_lshl_b32 s53, s53, 7
  s_add_u32 m0, s52, 16384
  s_nop 0
  buffer_load_dwordx4 v200, s[56:59], s53 offen lds
  buffer_load_dwordx4 v201, s[56:59], s53 offen offset:1024 lds
  s_lshl_b32 s53, s88, 1
  s_add_u32 s53, s53, 15
  s_bitcmp1_b32 s53, 3
  s_cselect_b32 s56, s46, s44
  s_cselect_b32 s57, s47, s45
  s_and_b32 s53, s53, 7
  s_lshl_b32 s53, s53, 7
  s_add_u32 m0, s52, 24576
  s_nop 0
  buffer_load_dwordx4 v200, s[56:59], s53 offen lds
  buffer_load_dwordx4 v201, s[56:59], s53 offen offset:1024 lds
  s_cmp_lg_u32 s3, 4
  s_cbranch_scc1 L_y_nopoll
  s_branch L_poll0_10
L_poll_9:
  s_sleep 2
L_poll0_10:
  buffer_load_dwordx2 v[228:229], v208, s[64:67], 0 offen sc1
  s_waitcnt vmcnt(0)
  v_cmp_eq_u32 s[76:77], s74, v228
  v_cmp_eq_u32 s[78:79], s75, v229
  s_nop 1
  s_and_b64 s[76:77], s[76:77], s[78:79]
  s_cmp_eq_u64 s[76:77], -1
  s_cbranch_scc0 L_poll_9
L_y_nopoll:
  s_waitcnt vmcnt(0)
  s_barrier
  s_add_u32 s53, s88, 0
  s_and_b32 s53, s53, 7
  s_lshl_b32 s53, s53, 8
  s_add_u32 s55, s53, 128
  s_add_u32 m0, s52, 32768
  s_nop 0
  buffer_load_dwordx4 v202, s[64:67], s53 offen lds
  buffer_load_dwordx4 v203, s[64:67], s53 offen offset:1024 lds
  s_add_u32 m0, s54, 32768
  s_nop 0
  buffer_load_dwordx4 v202, s[64:67], s55 offen lds
  buffer_load_dwordx4 v203, s[64:67], s55 offen offset:1024 lds
  s_add_u32 s53, s88, 1
  s_and_b32 s53, s53, 7
  s_lshl_b32 s53, s53, 8
  s_add_u32 s55, s53, 128
  s_add_u32 m0, s52, 49152
  s_nop 0
  buffer_load_dwordx4 v202, s[64:67], s53 offen lds
  buffer_load_dwordx4 v203, s[64:67], s53 offen offset:1024 lds
  s_add_u32 m0, s54, 49152
  s_nop 0
  buffer_load_dwordx4 v202, s[64:67], s55 offen lds
  buffer_load_dwordx4 v203, s[64:67], s55 offen offset:1024 lds
  s_add_u32 s53, s88, 2
  s_and_b32 s53, s53, 7
  s_lshl_b32 s53, s53, 8
  s_add_u32 s55, s53, 128
  s_add_u32 m0, s52, 131072
  s_nop 0
  buffer_load_dwordx4 v202, s[64:67], s53 offen lds
  buffer_load_dwordx4 v203, s[64:67], s53 offen offset:1024 lds
  s_add_u32 m0, s54, 131072
  s_nop 0
  buffer_load_dwordx4 v202, s[64:67], s55 offen lds
  buffer_load_dwordx4 v203, s[64:67], s55 offen offset:1024 lds
  s_add_u32 s53, s88, 3
  s_and_b32 s53, s53, 7
  s_lshl_b32 s53, s53, 8
  s_add_u32 s55, s53, 128
  s_add_u32 m0, s52, 147456
  s_nop 0
  buffer_load_dwordx4 v202, s[64:67], s53 offen lds
  buffer_load_dwordx4 v203, s[64:67], s53 offen offset:1024 lds
  s_add_u32 m0, s54, 147456
  s_nop 0
  buffer_load_dwordx4 v202, s[64:67], s55 offen lds
  buffer_load_dwordx4 v203, s[64:67], s55 offen offset:1024 lds
  s_waitcnt vmcnt(12)
  s_barrier
  s_waitcnt vmcnt(8)
  s_barrier
  s_add_u32 s53, s88, 4
  s_and_b32 s53, s53, 7
  s_lshl_b32 s53, s53, 8
  s_add_u32 s55, s53, 128
  s_add_u32 m0, s52, 32768
  s_nop 0
  buffer_load_dwordx4 v202, s[64:67], s53 offen lds
  buffer_load_dwordx4 v203, s[64:67], s53 offen offset:1024 lds
  s_add_u32 m0, s54, 32768
  s_nop 0
  buffer_load_dwordx4 v202, s[64:67], s55 offen lds
  buffer_load_dwordx4 v203, s[64:67], s55 offen offset:1024 lds
  s_waitcnt vmcnt(8)
  s_barrier
  s_add_u32 s53, s88, 5
  s_and_b32 s53, s53, 7
  s_lshl_b32 s53, s53, 8
  s_add_u32 s55, s53, 128
  s_add_u32 m0, s52, 49152
  s_nop 0
  buffer_load_dwordx4 v202, s[64:67], s53 offen lds
  buffer_load_dwordx4 v203, s[64:67], s53 offen offset:1024 lds
  s_add_u32 m0, s54, 49152
  s_nop 0
  buffer_load_dwordx4 v202, s[64:67], s55 offen lds
  buffer_load_dwordx4 v203, s[64:67], s55 offen offset:1024 lds
  s_waitcnt vmcnt(8)
  s_barrier
  s_add_u32 s53, s88, 6
  s_and_b32 s53, s53, 7
  s_lshl_b32 s53, s53, 8
  s_add_u32 s55, s53, 128
  s_add_u32 m0, s52, 131072
  s_nop 0
  buffer_load_dwordx4 v202, s[64:67], s53 offen lds
  buffer_load_dwordx4 v203, s[64:67], s53 offen offset:1024 lds
  s_add_u32 m0, s54, 131072
  s_nop 0
  buffer_load_dwordx4 v202, s[64:67], s55 offen lds
  buffer_load_dwordx4 v203, s[64:67], s55 offen offset:1024 lds
  s_waitcnt vmcnt(8)
  s_barrier
  s_add_u32 s53, s88, 7
  s_and_b32 s53, s53, 7
  s_lshl_b32 s53, s53, 8
  s_add_u32 s55, s53, 128
  s_add_u32 m0, s52, 147456
  s_nop 0
  buffer_load_dwordx4 v202, s[64:67], s53 offen lds
  buffer_load_dwordx4 v203, s[64:67], s53 offen offset:1024 lds
  s_add_u32 m0, s54, 147456
  s_nop 0
  buffer_load_dwordx4 v202, s[64:67], s55 offen lds
  buffer_load_dwordx4 v203, s[64:67], s55 offen offset:1024 lds
  s_waitcnt vmcnt(8)
  s_barrier
  s_waitcnt vmcnt(4)
  s_barrier
  s_waitcnt vmcnt(0)
  s_barrier
  s_branch L_pc_end
L_y_cons:
  s_nop 1
  ds_read_b128 v[116:119], v212 offset:0
  ds_read_b128 v[120:123], v213 offset:0
  ds_read_b128 v[124:127], v214 offset:0
  ds_read_b128 v[128:131], v215 offset:0
  ds_read_b128 v[132:135], v212 offset:8192
  ds_read_b128 v[136:139], v213 offset:8192
  ds_read_b128 v[140:143], v214 offset:8192
  ds_read_b128 v[144:147], v215 offset:8192
  ds_read_b128 v[148:151], v212 offset:16384
  ds_read_b128 v[152:155], v213 offset:16384
  ds_read_b128 v[156:159], v214 offset:16384
  ds_read_b128 v[160:163], v215 offset:16384
  ds_read_b128 v[164:167], v212 offset:24576
  ds_read_b128 v[168:171], v213 offset:24576
  ds_read_b128 v[172:175], v214 offset:24576
  ds_read_b128 v[176:179], v215 offset:24576
  ds_read_b128 v[180:183], v216 offset:0
  ds_read_b128 v[184:187], v217 offset:0
  ds_read_b128 v[188:191], v218 offset:0
  ds_read_b128 v[192:195], v219 offset:0
  ds_read_b128 v[196:199], v216 offset:8192
  ds_read_b128 v[200:203], v217 offset:8192
  ds_read_b128 v[204:207], v218 offset:8192
  ds_read_b128 v[208:211], v219 offset:8192
  s_mov_b32 s24, s50
  s_mov_b32 s25, s51
  s_mov_b32 s26, 4194304
  s_mov_b32 s27, 0x00020000
  s_waitcnt lgkmcnt(0)
  s_barrier
  s_barrier
  s_barrier
  ds_read_b128 v[52:55], v220 offset:32768
  ds_read_b128 v[56:59], v221 offset:32768
  ds_read_b128 v[60:63], v222 offset:32768
  ds_read_b128 v[64:67], v223 offset:32768
  ds_read_b128 v[68:71], v220 offset:40960
  ds_read_b128 v[72:75], v221 offset:40960
  ds_read_b128 v[76:79], v222 offset:40960
  ds_read_b128 v[80:83], v223 offset:40960
  s_waitcnt lgkmcnt(0)
  s_barrier
  v_mfma_f32_32x32x16_bf16 v[20:35], v[116:119], v[52:55], 0
  ds_read_b128 v[84:87], v220 offset:49152
  ds_read_b128 v[88:91], v221 offset:49152
  ds_read_b128 v[92:95], v222 offset:49152
  v_mfma_f32_32x32x16_bf16 v[20:35], v[120:123], v[56:59], v[20:35]
  ds_read_b128 v[96:99], v223 offset:49152
  ds_read_b128 v[100:103], v220 offset:57344
  ds_read_b128 v[104:107], v221 offset:57344
  v_mfma_f32_32x32x16_bf16 v[20:35], v[124:127], v[60:63], v[20:35]
  ds_read_b128 v[108:111], v222 offset:57344
  ds_read_b128 v[112:115], v223 offset:57344
  v_mfma_f32_32x32x16_bf16 v[20:35], v[128:131], v[64:67], v[20:35]
  v_mfma_f32_32x32x16_bf16 v[20:35], v[132:135], v[68:71], v[20:35]
  v_mfma_f32_32x32x16_bf16 v[20:35], v[136:139], v[72:75], v[20:35]
  ds_read_b128 v[116:119], v216 offset:16384
  ds_read_b128 v[120:123], v217 offset:16384
  v_mfma_f32_32x32x16_bf16 v[20:35], v[140:143], v[76:79], v[20:35]
  ds_read_b128 v[124:127], v218 offset:16384
  ds_read_b128 v[128:131], v219 offset:16384
  v_mfma_f32_32x32x16_bf16 v[20:35], v[144:147], v[80:83], v[20:35]
  s_waitcnt lgkmcnt(4)
  s_barrier
  v_mfma_f32_32x32x16_bf16 v[20:35], v[148:151], v[84:87], v[20:35]
  ds_read_b128 v[52:55], v224 offset:0
  ds_read_b128 v[56:59], v225 offset:0
  ds_read_b128 v[60:63], v226 offset:0
  v_mfma_f32_32x32x16_bf16 v[20:35], v[152:155], v[88:91], v[20:35]
  ds_read_b128 v[64:67], v227 offset:0
  ds_read_b128 v[68:71], v224 offset:8192
  ds_read_b128 v[72:75], v225 offset:8192
  v_mfma_f32_32x32x16_bf16 v[20:35], v[156:159], v[92:95], v[20:35]
  ds_read_b128 v[76:79], v226 offset:8192
  ds_read_b128 v[80:83], v227 offset:8192
  v_mfma_f32_32x32x16_bf16 v[20:35], v[160:163], v[96:99], v[20:35]
  ds_read_b128 v[132:135], v216 offset:24576
  ds_read_b128 v[136:139], v217 offset:24576
  v_mfma_f32_32x32x16_bf16 v[20:35], v[164:167], v[100:103], v[20:35]
  ds_read_b128 v[140:143], v218 offset:24576
  ds_read_b128 v[144:147], v219 offset:24576
  v_mfma_f32_32x32x16_bf16 v[20:35], v[168:171], v[104:107], v[20:35]
  ds_read_b128 v[148:151], v216 offset:32768
  ds_read_b128 v[152:155], v217 offset:32768
  v_mfma_f32_32x32x16_bf16 v[20:35], v[172:175], v[108:111], v[20:35]
  ds_read_b128 v[156:159], v218 offset:32768
  ds_read_b128 v[160:163], v219 offset:32768
  v_mfma_f32_32x32x16_bf16 v[20:35], v[176:179], v[112:115], v[20:35]
  s_waitcnt lgkmcnt(8)
  s_barrier
  v_mfma_f32_32x32x16_bf16 v[20:35], v[180:183], v[52:55], v[20:35]
  ds_read_b128 v[84:87], v224 offset:16384
  ds_read_b128 v[88:91], v225 offset:16384
  ds_read_b128 v[92:95], v226 offset:16384
  v_mfma_f32_32x32x16_bf16 v[20:35], v[184:187], v[56:59], v[20:35]
  ds_read_b128 v[96:99], v227 offset:16384
  ds_read_b128 v[100:103], v224 offset:24576
  ds_read_b128 v[104:107], v225 offset:24576
  v_mfma_f32_32x32x16_bf16 v[20:35], v[188:191], v[60:63], v[20:35]
  ds_read_b128 v[108:111], v226 offset:24576
  ds_read_b128 v[112:115], v227 offset:24576
  v_mfma_f32_32x32x16_bf16 v[20:35], v[192:195], v[64:67], v[20:35]
  ds_read_b128 v[164:167], v216 offset:40960
  ds_read_b128 v[168:171], v217 offset:40960
  v_mfma_f32_32x32x16_bf16 v[20:35], v[196:199], v[68:71], v[20:35]
  ds_read_b128 v[172:175], v218 offset:40960
  ds_read_b128 v[176:179], v219 offset:40960
  v_mfma_f32_32x32x16_bf16 v[20:35], v[200:203], v[72:75], v[20:35]
  ds_read_b128 v[180:183], v216 offset:49152
  ds_read_b128 v[184:187], v217 offset:49152
  v_mfma_f32_32x32x16_bf16 v[20:35], v[204:207], v[76:79], v[20:35]
  ds_read_b128 v[188:191], v218 offset:49152
  ds_read_b128 v[192:195], v219 offset:49152
  v_mfma_f32_32x32x16_bf16 v[20:35], v[208:211], v[80:83], v[20:35]
  s_waitcnt lgkmcnt(8)
  s_barrier
  v_mfma_f32_32x32x16_bf16 v[20:35], v[116:119], v[84:87], v[20:35]
  ds_read_b128 v[52:55], v220 offset:32768
  ds_read_b128 v[56:59], v221 offset:32768
  ds_read_b128 v[60:63], v222 offset:32768
  v_mfma_f32_32x32x16_bf16 v[20:35], v[120:123], v[88:91], v[20:35]
  ds_read_b128 v[64:67], v223 offset:32768
  ds_read_b128 v[68:71], v220 offset:40960
  ds_read_b128 v[72:75], v221 offset:40960
  v_mfma_f32_32x32x16_bf16 v[20:35], v[124:127], v[92:95], v[20:35]
  ds_read_b128 v[76:79], v222 offset:40960
  ds_read_b128 v[80:83], v223 offset:40960
  v_mfma_f32_32x32x16_bf16 v[20:35], v[128:131], v[96:99], v[20:35]
  ds_read_b128 v[196:199], v216 offset:57344
  ds_read_b128 v[200:203], v217 offset:57344
  v_mfma_f32_32x32x16_bf16 v[20:35], v[132:135], v[100:103], v[20:35]
  ds_read_b128 v[204:207], v218 offset:57344
  ds_read_b128 v[208:211], v219 offset:57344
  v_mfma_f32_32x32x16_bf16 v[20:35], v[136:139], v[104:107], v[20:35]
  ds_read_b128 v[116:119], v212 offset:0
  ds_read_b128 v[120:123], v213 offset:0
  v_mfma_f32_32x32x16_bf16 v[20:35], v[140:143], v[108:111], v[20:35]
  ds_read_b128 v[124:127], v214 offset:0
  ds_read_b128 v[128:131], v215 offset:0
  v_mfma_f32_32x32x16_bf16 v[20:35], v[144:147], v[112:115], v[20:35]
  s_waitcnt lgkmcnt(8)
  s_barrier
  v_mfma_f32_32x32x16_bf16 v[20:35], v[148:151], v[52:55], v[20:35]
  ds_read_b128 v[84:87], v220 offset:49152
  ds_read_b128 v[88:91], v221 offset:49152
  ds_read_b128 v[92:95], v222 offset:49152
  v_mfma_f32_32x32x16_bf16 v[20:35], v[152:155], v[56:59], v[20:35]
  ds_read_b128 v[96:99], v223 offset:49152
  ds_read_b128 v[100:103], v220 offset:57344
  ds_read_b128 v[104:107], v221 offset:57344
  v_mfma_f32_32x32x16_bf16 v[20:35], v[156:159], v[60:63], v[20:35]
  ds_read_b128 v[108:111], v222 offset:57344
  ds_read_b128 v[112:115], v223 offset:57344
  v_mfma_f32_32x32x16_bf16 v[20:35], v[160:163], v[64:67], v[20:35]
  ds_read_b128 v[132:135], v212 offset:8192
  ds_read_b128 v[136:139], v213 offset:8192
  v_mfma_f32_32x32x16_bf16 v[20:35], v[164:167], v[68:71], v[20:35]
  ds_read_b128 v[140:143], v214 offset:8192
  ds_read_b128 v[144:147], v215 offset:8192
  v_mfma_f32_32x32x16_bf16 v[20:35], v[168:171], v[72:75], v[20:35]
  ds_read_b128 v[148:151], v212 offset:16384
  ds_read_b128 v[152:155], v213 offset:16384
  v_mfma_f32_32x32x16_bf16 v[20:35], v[172:175], v[76:79], v[20:35]
  ds_read_b128 v[156:159], v214 offset:16384
  ds_read_b128 v[160:163], v215 offset:16384
  v_mfma_f32_32x32x16_bf16 v[20:35], v[176:179], v[80:83], v[20:35]
  s_waitcnt lgkmcnt(8)
  s_barrier
  v_mfma_f32_32x32x16_bf16 v[20:35], v[180:183], v[84:87], v[20:35]
  ds_read_b128 v[52:55], v224 offset:0
  ds_read_b128 v[56:59], v225 offset:0
  ds_read_b128 v[60:63], v226 offset:0
  v_mfma_f32_32x32x16_bf16 v[20:35], v[184:187], v[88:91], v[20:35]
  ds_read_b128 v[64:67], v227 offset:0
  ds_read_b128 v[68:71], v224 offset:8192
  ds_read_b128 v[72:75], v225 offset:8192
  v_mfma_f32_32x32x16_bf16 v[20:35], v[188:191], v[92:95], v[20:35]
  ds_read_b128 v[76:79], v226 offset:8192
  ds_read_b128 v[80:83], v227 offset:8192
  v_mfma_f32_32x32x16_bf16 v[20:35], v[192:195], v[96:99], v[20:35]
  ds_read_b128 v[164:167], v212 offset:24576
  ds_read_b128 v[168:171], v213 offset:24576
  v_mfma_f32_32x32x16_bf16 v[20:35], v[196:199], v[100:103], v[20:35]
  ds_read_b128 v[172:175], v214 offset:24576
  ds_read_b128 v[176:179], v215 offset:24576
  v_mfma_f32_32x32x16_bf16 v[20:35], v[200:203], v[104:107], v[20:35]
  v_mfma_f32_32x32x16_bf16 v[20:35], v[204:207], v[108:111], v[20:35]
  v_mfma_f32_32x32x16_bf16 v[20:35], v[208:211], v[112:115], v[20:35]
  s_waitcnt lgkmcnt(4)
  s_barrier
  v_mfma_f32_32x32x16_bf16 v[20:35], v[116:119], v[52:55], v[20:35]
  ds_read_b128 v[84:87], v224 offset:16384
  ds_read_b128 v[88:91], v225 offset:16384
  ds_read_b128 v[92:95], v226 offset:16384
  v_mfma_f32_32x32x16_bf16 v[20:35], v[120:123], v[56:59], v[20:35]
  ds_read_b128 v[96:99], v227 offset:16384
  ds_read_b128 v[100:103], v224 offset:24576
  ds_read_b128 v[104:107], v225 offset:24576
  v_mfma_f32_32x32x16_bf16 v[20:35], v[124:127], v[60:63], v[20:35]
  ds_read_b128 v[108:111], v226 offset:24576
  ds_read_b128 v[112:115], v227 offset:24576
  v_mfma_f32_32x32x16_bf16 v[20:35], v[128:131], v[64:67], v[20:35]
  v_mfma_f32_32x32x16_bf16 v[20:35], v[132:135], v[68:71], v[20:35]
  v_mfma_f32_32x32x16_bf16 v[20:35], v[136:139], v[72:75], v[20:35]
  v_mfma_f32_32x32x16_bf16 v[20:35], v[140:143], v[76:79], v[20:35]
  v_mfma_f32_32x32x16_bf16 v[20:35], v[144:147], v[80:83], v[20:35]
  s_waitcnt lgkmcnt(0)
  v_mfma_f32_32x32x16_bf16 v[20:35], v[148:151], v[84:87], v[20:35]
  v_mfma_f32_32x32x16_bf16 v[20:35], v[152:155], v[88:91], v[20:35]
  v_mfma_f32_32x32x16_bf16 v[20:35], v[156:159], v[92:95], v[20:35]
  v_mfma_f32_32x32x16_bf16 v[20:35], v[160:163], v[96:99], v[20:35]
  v_mfma_f32_32x32x16_bf16 v[20:35], v[164:167], v[100:103], v[20:35]
  v_mfma_f32_32x32x16_bf16 v[20:35], v[168:171], v[104:107], v[20:35]
  v_mfma_f32_32x32x16_bf16 v[20:35], v[172:175], v[108:111], v[20:35]
  v_mfma_f32_32x32x16_bf16 v[20:35], v[176:179], v[112:115], v[20:35]
  s_nop 7
  s_nop 7
  v_cvt_pk_bf16_f32 v8, v20, v21
  v_cvt_pk_bf16_f32 v9, v22, v23
  v_cvt_pk_bf16_f32 v10, v24, v25
  v_cvt_pk_bf16_f32 v11, v26, v27
  v_cvt_pk_bf16_f32 v12, v28, v29
  v_cvt_pk_bf16_f32 v13, v30, v31
  v_cvt_pk_bf16_f32 v14, v32, v33
  v_cvt_pk_bf16_f32 v15, v34, v35
  s_nop 1
  v_permlane32_swap_b32 v8, v10
  v_permlane32_swap_b32 v9, v11
  v_permlane32_swap_b32 v12, v14
  v_permlane32_swap_b32 v13, v15
  s_nop 1
  buffer_store_dwordx4 v[8:11], v238, s[24:27], 0 offen offset:0
  buffer_store_dwordx4 v[12:15], v238, s[24:27], 0 offen offset:32
L_pc_end:
L_exit:
  s_endpgm
.section .rodata,"a"
.p2align 6
.amdhsa_kernel concat_heads__spectral_fnet__sliding_local_dilated__prompt_kernel
  .amdhsa_next_free_vgpr 256
  .amdhsa_next_free_sgpr 102
  .amdhsa_accum_offset 256
  .amdhsa_group_segment_fixed_size 0
  .amdhsa_kernarg_size 88
  .amdhsa_user_sgpr_count 2
  .amdhsa_user_sgpr_kernarg_segment_ptr 1
  .amdhsa_system_sgpr_workgroup_id_x 1
  .amdhsa_float_denorm_mode_32 3
.end_amdhsa_kernel
```
